```python
import torch

def _softmax(x, axis=-1):
    return torch.softmax(x, dim=axis)
def _gelu(x):
    return torch.nn.functional.gelu(x, approximate="tanh")
def _silu(x):
    return torch.nn.functional.silu(x)
def _sigmoid(x):
    return torch.sigmoid(x)
def _layernorm(x, axis=-1, eps=1e-5):
    m = x.mean(dim=axis, keepdim=True)
    v = x.var(dim=axis, keepdim=True, unbiased=False)
    return (x - m) / torch.sqrt(v + eps)
def _scatter_add(tgt, idx, src, axis=0):
    return tgt.clone().index_add_(axis, idx, src)
def _segment_sum(src, seg, n):
    out = torch.zeros((n,) + src.shape[1:], dtype=src.dtype)
    return out.index_add_(0, seg, src)
def _pad(x, pw):
    flat = tuple(v for pair in reversed(pw) for v in pair)
    return torch.nn.functional.pad(x, flat)

kernel_name = 'gated_mix__ssm_conv_s5__glu_gated_bilinear__prompt'

def setup_inputs():

    _w = (lambda a: (lambda t: t.to(torch.bfloat16) if t.is_floating_point() else t)(torch.as_tensor(a)))
    def _A_setup():
        B, S, D = 1, 2048, 640
        P = D
        Lambda_re = -0.5 * (lambda _x: torch.exp(torch.as_tensor(_x)))((lambda *s: torch.randn(*s, dtype=torch.bfloat16) * 0.2)(P))
        Lambda_im = (lambda *s: torch.randn(*s, dtype=torch.bfloat16) * 0.4)(P) * 1.0
        B_re = (lambda *s: torch.randn(*s, dtype=torch.bfloat16) * 0.2)(P, D) * (D ** -0.5)
        B_im = (lambda *s: torch.randn(*s, dtype=torch.bfloat16) * 0.2)(P, D) * (D ** -0.5)
        C_re = (lambda *s: torch.randn(*s, dtype=torch.bfloat16) * 0.2)(D, P) * (P ** -0.5)
        C_im = (lambda *s: torch.randn(*s, dtype=torch.bfloat16) * 0.2)(D, P) * (P ** -0.5)
        log_dt = (lambda *s: torch.randn(*s, dtype=torch.bfloat16) * 0.2)(P) * 0.3 - 2.0
        Dskip = (lambda *s: torch.randn(*s, dtype=torch.bfloat16) * 0.05)(D)
        return {
            "x": _w((lambda *s: torch.randn(*s, dtype=torch.bfloat16) * 0.05)(B, S, D)),
            "Lambda_re": _w(Lambda_re),
            "Lambda_im": _w(Lambda_im),
            "B_re": _w(B_re),
            "B_im": _w(B_im),
            "C_re": _w(C_re),
            "C_im": _w(C_im),
            "log_dt": _w(log_dt),
            "Dskip": _w(Dskip),
        }
    _A_in = _A_setup()

    def _B_setup():
        B, S, D, F = 1, 2048, 640, 1536
        return {
            "x": _w((lambda *s: torch.randn(*s, dtype=torch.bfloat16) * 0.05)(B, S, D)),
            "w_gate": _w((lambda *s: torch.randn(*s, dtype=torch.bfloat16) * 0.8)(D, F) * (D ** -0.5)),
            "w_up": _w((lambda *s: torch.randn(*s, dtype=torch.bfloat16) * 0.8)(D, F) * (D ** -0.5)),
            "w_down": _w((lambda *s: torch.randn(*s, dtype=torch.bfloat16) * 0.8)(F, D) * (F ** -0.5)),
        }
    _B_in = _B_setup()

    return {
        "A_x": _A_in["x"],
        "A_Lambda_re": _A_in["Lambda_re"],
        "A_Lambda_im": _A_in["Lambda_im"],
        "A_B_re": _A_in["B_re"],
        "A_B_im": _A_in["B_im"],
        "A_C_re": _A_in["C_re"],
        "A_C_im": _A_in["C_im"],
        "A_log_dt": _A_in["log_dt"],
        "A_Dskip": _A_in["Dskip"],
        "B_x": _B_in["x"],
        "B_w_gate": _B_in["w_gate"],
        "B_w_up": _B_in["w_up"],
        "B_w_down": _B_in["w_down"],
        "gate_w": _w((lambda *s: torch.randn(*s, dtype=torch.bfloat16) * 0.05)(640) * 16.0),
    }

def reference(A_x, A_Lambda_re, A_Lambda_im, A_B_re, A_B_im, A_C_re, A_C_im, A_log_dt, A_Dskip, B_x, B_w_gate, B_w_up, B_w_down, gate_w):
    def _A_ref(x, Lambda_re, Lambda_im, B_re, B_im, C_re, C_im, log_dt, Dskip):
        Bsz, L, H = x.shape
        Lam = Lambda_re + 1j * Lambda_im
        Bmat = B_re + 1j * B_im
        Cmat = C_re + 1j * C_im
        dt = torch.exp(log_dt)
        Lam_bar = torch.exp(dt * Lam)
        B_bar = ((Lam_bar - 1.0) / Lam)[:, None] * Bmat
        Bu = torch.einsum("bld,pd->blp", x + 0j, B_bar)
        h = torch.zeros_like(Bu[:, 0, :])
        hs = []
        for t in range(L):
            h = Lam_bar[None, :] * h + Bu[:, t, :]
            hs.append(h)
        hseq = torch.stack(hs, 1)
        y = 2.0 * torch.einsum("blp,dp->bld", hseq, Cmat).real + x * Dskip[None, None, :]
        return y

    def _B_ref(x, w_gate, w_up, w_down):
        g = torch.einsum("bsd,df->bsf", x, w_gate)
        u = torch.einsum("bsd,df->bsf", x, w_up)
        h = g * u
        return torch.einsum("bsf,fd->bsd", h, w_down)

    x = A_x
    g = _sigmoid((x * gate_w).sum(-1, keepdims=True))
    a = _A_ref(x, A_Lambda_re, A_Lambda_im, A_B_re, A_B_im, A_C_re, A_C_im, A_log_dt, A_Dskip)
    b = _B_ref(x, B_w_gate, B_w_up, B_w_down)
    return g * a + (1 - g) * b
```

```asm
; @launch grid=(256,1,1) block=(256,1,1) lds=163840
.amdgcn_target "amdgcn-amd-amdhsa--gfx950"
.text
.globl gated_mix__ssm_conv_s5__glu_gated_bilinear__prompt_kernel
.p2align 8
.type gated_mix__ssm_conv_s5__glu_gated_bilinear__prompt_kernel,@function
gated_mix__ssm_conv_s5__glu_gated_bilinear__prompt_kernel:
    s_cmp_ge_u32 s2, 256
    s_cbranch_scc1 L_end
    s_getpc_b64 s[40:41]
L_pc:
    v_lshlrev_b32 v2, 2, v0
    s_lshr_b32 s42, s2, 3
    s_lshl_b32 s42, s42, 10
    v_add_u32 v2, s42, v2
    v_min_u32 v2, L_codeend-L_pc-4, v2
    v_mov_b32 v3, s41
    v_add_co_u32 v2, vcc, s40, v2
    v_addc_co_u32 v3, vcc, 0, v3, vcc
    global_load_dword v99, v[2:3], off
    s_load_dwordx16 s[4:19], s[0:1], 0
    s_load_dwordx8 s[20:27], s[0:1], 64
    s_load_dwordx8 s[28:35], s[0:1], 96
    s_load_dwordx2 s[36:37], s[0:1], 128
    s_memrealtime s[38:39]
    v_lshrrev_b32 v19, 6, v0
    v_and_b32 v1, 63, v0
    s_and_b32 s87, s2, 1
    v_readfirstlane_b32 s68, v19
    s_lshl_b32 s87, s87, 3
    s_lshr_b32 s88, s2, 3
    s_and_b32 s71, s88, 7
    s_add_u32 s71, s71, s87
    s_lshr_b32 s87, s2, 1
    s_and_b32 s87, s87, 3
    s_lshl_b32 s89, s87, 2
    s_lshr_b32 s93, s2, 6
    s_add_u32 s72, s89, s93
    s_lshl_b32 s87, s87, 3
    s_and_b32 s88, s88, 7
    s_add_u32 s91, s87, s88
    s_and_b32 s87, s2, 1
    s_lshl_b32 s87, s87, 2
    s_add_u32 s92, s87, s93
    s_lshr_b32 s69, s68, 1
    s_and_b32 s70, s68, 1
    v_lshrrev_b32 v19, 3, v1
    v_and_b32 v20, 2, v19
    s_lshl_b32 s87, s70, 2
    v_or_b32 v20, s87, v20
    v_and_b32 v21, 7, v1
    v_xor_b32 v20, v20, v21
    s_lshl_b32 s87, s71, 7
    s_lshl_b32 s88, s68, 5
    s_add_u32 s87, s87, s88
    v_add_u32 v19, s87, v19
    v_mul_u32_u24 v19, 1280, v19
    v_lshl_add_u32 v2, v20, 4, v19
    v_add_u32 v3, 9216, v2
    v_add_u32 v4, 18432, v2
    v_add_u32 v5, 27648, v2
    s_lshl_b32 s82, s68, 12
    s_mul_i32 s83, s68, 3072
    s_add_u32 s84, s83, 28672
    s_add_u32 s83, s83, 16384
    s_and_b32 s87, s71, 7
    s_and_b32 s88, s72, 3
    s_add_u32 s87, s87, s88
    s_cmp_ge_u32 s87, 5
    s_cselect_b32 s88, 5, 0
    s_sub_u32 s87, s87, s88
    s_cmp_ge_u32 s87, 5
    s_cselect_b32 s88, 5, 0
    s_sub_u32 s87, s87, s88
    s_lshl_b32 s78, s87, 8
    s_mul_i32 s79, s78, 1536
    s_mov_b32 s80, s79
    s_mov_b32 s81, s78
    s_waitcnt lgkmcnt(0)
    s_or_b32 s87, s2, s68
    s_cmp_lg_u32 s87, 0
    s_cbranch_scc1 L_no_nonce
    s_or_b32 s87, s38, 1
    v_mov_b32 v19, s87
    v_mov_b32 v20, 0
    s_mov_b64 exec, 1
    global_store_dword v20, v19, s[34:35] sc1
    s_mov_b64 exec, -1
L_no_nonce:
    s_mov_b32 s40, s4
    s_mov_b32 s41, s5
    s_mov_b32 s42, 2621440
    s_mov_b32 s43, 0x00020000
    s_add_u32 m0, s82, 0
    s_nop 0
    buffer_load_dwordx4 v2, s[40:43], s78 offen lds
    s_mul_i32 s87, s68, 192
    s_mul_i32 s88, s72, 192
    v_add_u32 v19, s87, v1
    v_mul_u32_u24 v20, 43691, v19
    v_lshrrev_b32 v20, 19, v20
    v_mul_u32_u24 v21, 12, v20
    v_sub_u32 v21, v19, v21
    v_lshrrev_b32 v22, 2, v20
    v_and_b32 v22, 2, v22
    v_xor_b32 v21, v21, v22
    v_mul_u32_u24 v20, 3072, v20
    buffer_load_dwordx4 v3, s[40:43], s78 offen offset:1024 lds
    v_lshl_add_u32 v20, v21, 4, v20
    v_add_u32 v6, s88, v20
    v_add_u32 v19, s87, v1
    v_add_u32 v19, 64, v19
    v_mul_u32_u24 v20, 43691, v19
    v_lshrrev_b32 v20, 19, v20
    v_mul_u32_u24 v21, 12, v20
    v_sub_u32 v21, v19, v21
    v_lshrrev_b32 v22, 2, v20
    v_and_b32 v22, 2, v22
    v_xor_b32 v21, v21, v22
    v_mul_u32_u24 v20, 3072, v20
    buffer_load_dwordx4 v4, s[40:43], s78 offen offset:2048 lds
    v_lshl_add_u32 v20, v21, 4, v20
    v_add_u32 v7, s88, v20
    v_subrev_u32 v7, 1024, v7
    v_add_u32 v19, s87, v1
    v_add_u32 v19, 128, v19
    v_mul_u32_u24 v20, 43691, v19
    v_lshrrev_b32 v20, 19, v20
    v_mul_u32_u24 v21, 12, v20
    v_sub_u32 v21, v19, v21
    v_lshrrev_b32 v22, 2, v20
    v_and_b32 v22, 2, v22
    v_xor_b32 v21, v21, v22
    buffer_load_dwordx4 v5, s[40:43], s78 offen offset:3072 lds
    v_mul_u32_u24 v20, 3072, v20
    v_lshl_add_u32 v20, v21, 4, v20
    v_add_u32 v8, s88, v20
    v_subrev_u32 v8, 2048, v8
    s_mov_b32 s44, s24
    s_mov_b32 s45, s25
    s_mov_b32 s46, 1966080
    s_mov_b32 s47, 0x00020000
    s_mov_b32 s48, s26
    s_mov_b32 s49, s27
    s_mov_b32 s50, 1966080
    s_mov_b32 s51, 0x00020000
    s_add_u32 m0, s83, 0
    s_nop 0
    buffer_load_dwordx4 v6, s[44:47], s79 offen lds
    s_mul_i32 s93, s72, 40
    s_mul_i32 s89, s68, 3
    s_cmp_eq_u32 s68, 3
    s_cselect_b32 s89, 8, s89
    s_add_u32 s75, s89, 2
    s_cmp_ge_u32 s68, 2
    s_cselect_b32 s87, 1, 0
    s_sub_u32 s75, s75, s87
    s_lshl_b32 s85, s89, 10
    s_add_u32 s85, s85, 40960
    s_lshl_b32 s86, s75, 10
    s_add_u32 s86, s86, 40960
    buffer_load_dwordx4 v7, s[44:47], s79 offen offset:1024 lds
    v_lshrrev_b32 v22, 4, v1
    v_lshlrev_b32 v22, 1, v22
    v_and_b32 v23, 7, v1
    s_mov_b32 s87, s89
    s_cmp_ge_u32 s87, 5
    s_cselect_b32 s88, 1, 0
    s_cselect_b32 s76, 5, 0
    s_sub_u32 s87, s87, s76
    s_lshl_b32 s87, s87, 3
    s_add_u32 s87, s87, s93
    v_lshrrev_b32 v19, 3, v1
    v_add_u32 v19, s87, v19
    buffer_load_dwordx4 v8, s[44:47], s79 offen offset:2048 lds
    v_mul_u32_u24 v19, 1280, v19
    v_add_u32 v20, s88, v22
    v_xor_b32 v20, v20, v23
    v_lshl_add_u32 v19, v20, 4, v19
    v_add_u32 v9, 4096, v19
    s_add_u32 s87, s89, 1
    s_cmp_ge_u32 s87, 5
    s_cselect_b32 s88, 1, 0
    s_cselect_b32 s76, 5, 0
    s_sub_u32 s87, s87, s76
    s_lshl_b32 s87, s87, 3
    s_add_u32 s87, s87, s93
    s_add_u32 m0, s84, 0
    s_nop 0
    buffer_load_dwordx4 v6, s[48:51], s80 offen lds
    v_lshrrev_b32 v19, 3, v1
    v_add_u32 v19, s87, v19
    v_mul_u32_u24 v19, 1280, v19
    v_add_u32 v20, s88, v22
    v_xor_b32 v20, v20, v23
    v_lshl_add_u32 v19, v20, 4, v19
    v_add_u32 v10, 3072, v19
    s_mov_b32 s87, s75
    s_cmp_ge_u32 s87, 5
    s_cselect_b32 s88, 1, 0
    s_cselect_b32 s76, 5, 0
    s_sub_u32 s87, s87, s76
    buffer_load_dwordx4 v7, s[48:51], s80 offen offset:1024 lds
    s_lshl_b32 s87, s87, 3
    s_add_u32 s87, s87, s93
    v_lshrrev_b32 v19, 3, v1
    v_add_u32 v19, s87, v19
    v_mul_u32_u24 v19, 1280, v19
    v_add_u32 v20, s88, v22
    v_xor_b32 v20, v20, v23
    v_lshl_add_u32 v19, v20, 4, v19
    v_add_u32 v11, 4096, v19
    s_cmp_ge_u32 s68, 2
    s_cselect_b32 s52, s12, s10
    s_cselect_b32 s53, s13, s11
    buffer_load_dwordx4 v8, s[48:51], s80 offen offset:2048 lds
    s_sub_u32 s52, s52, 4096
    s_subb_u32 s53, s53, 0
    s_mov_b32 s54, 823296
    s_mov_b32 s55, 0x00020000
    s_cmp_ge_u32 s68, 2
    s_cselect_b32 s56, s12, s10
    s_cselect_b32 s57, s13, s11
    s_sub_u32 s56, s56, 4096
    s_subb_u32 s57, s57, 0
    s_mov_b32 s58, 823296
    s_mov_b32 s59, 0x00020000
    s_cmp_ge_u32 s68, 1
    s_cselect_b32 s60, s12, s10
    s_cselect_b32 s61, s13, s11
    s_sub_u32 s60, s60, 4096
    s_subb_u32 s61, s61, 0
    s_mov_b32 s62, 823296
    s_mov_b32 s63, 0x00020000
    s_add_u32 m0, s85, 0
    s_nop 0
    buffer_load_dwordx4 v9, s[52:55], s81 offen lds
    v_and_b32 v19, 15, v1
    v_lshrrev_b32 v19, 1, v19
    v_lshlrev_b32 v19, 1, v19
    v_add_u32 v70, 162112, v19
    s_lshl_b32 s88, s70, 5
    v_add_u32 v69, s88, v19
    v_add_u32 v69, 162048, v69
    s_mul_i32 s87, s72, 80
    v_lshlrev_b32 v20, 2, v1
    v_add_u32 v74, s87, v20
    s_mul_i32 s87, s2, 52429
    s_lshr_b32 s87, s87, 18
    s_mul_i32 s88, s87, 5
    s_sub_u32 s88, s2, s88
    v_lshrrev_b32 v19, 2, v1
    s_lshl_b32 s89, s87, 5
    v_add_u32 v19, s89, v19
    v_mul_u32_u24 v19, 1280, v19
    v_and_b32 v20, 3, v1
    v_lshl_add_u32 v19, v20, 4, v19
    s_lshl_b32 s89, s88, 8
    v_add_u32 v19, s89, v19
    s_lshl_b32 s89, s68, 6
    v_add_u32 v61, s89, v19
    v_add_u32 v62, 19456, v61
    s_lshl_b32 s89, s88, 3
    s_lshl_b32 s93, s68, 1
    s_add_u32 s89, s89, s93
    s_mul_i32 s93, s89, 52429
    s_lshr_b32 s93, s93, 18
    buffer_load_dwordx4 v10, s[56:59], s81 offen offset:1024 lds
    s_mul_i32 s75, s93, 5
    s_sub_u32 s89, s89, s75
    s_mul_i32 s93, s93, 88
    s_add_u32 s93, s93, s87
    s_add_u32 s93, s93, 40
    s_mul_i32 s93, s93, 5
    s_add_u32 s93, s93, s89
    s_lshl_b32 s93, s93, 10
    s_add_u32 s93, s93, 12582912
    v_lshlrev_b32 v64, 4, v1
    v_add_u32 v64, s93, v64
    s_lshl_b32 s89, s88, 3
    s_lshl_b32 s93, s68, 1
    s_add_u32 s89, s89, s93
    s_add_u32 s89, s89, 1
    s_mul_i32 s93, s89, 52429
    s_lshr_b32 s93, s93, 18
    s_mul_i32 s75, s93, 5
    s_sub_u32 s89, s89, s75
    s_mul_i32 s93, s93, 88
    s_add_u32 s93, s93, s87
    s_add_u32 s93, s93, 40
    s_mul_i32 s93, s93, 5
    s_add_u32 s93, s93, s89
    s_lshl_b32 s93, s93, 10
    s_add_u32 s93, s93, 12582912
    v_lshlrev_b32 v65, 4, v1
    v_add_u32 v65, s93, v65
    s_lshl_b32 s87, s2, 3
    s_lshl_b32 s88, s68, 1
    s_add_u32 m0, s86, 0
    s_nop 0
    buffer_load_dwordx4 v11, s[60:63], s81 offen lds
    s_add_u32 s87, s87, s88
    s_mul_i32 s88, s87, 52429
    s_lshr_b32 s88, s88, 21
    s_mul_i32 s89, s88, 40
    s_sub_u32 s87, s87, s89
    s_cmp_ge_u32 s87, 20
    s_cselect_b32 s76, 1, 0
    s_cselect_b32 s89, 20, 0
    s_sub_u32 s89, s87, s89
    v_and_b32 v19, 15, v1
    s_lshl_b32 s93, s88, 4
    v_add_u32 v19, s93, v19
    v_mul_u32_u24 v19, 1280, v19
    v_lshrrev_b32 v20, 4, v1
    v_lshl_add_u32 v19, v20, 4, v19
    s_lshl_b32 s89, s89, 6
    v_add_u32 v63, s89, v19
    s_mul_i32 s93, s88, 52429
    s_lshr_b32 s93, s93, 18
    s_mul_i32 s75, s93, 5
    s_sub_u32 s88, s88, s75
    s_mul_i32 s93, s93, 88
    s_add_u32 s93, s93, s87
    s_mul_i32 s93, s93, 5
    s_add_u32 s93, s93, s88
    s_lshl_b32 s93, s93, 10
    s_add_u32 s93, s93, 12582912
    v_lshlrev_b32 v66, 4, v1
    v_add_u32 v66, s93, v66
    v_add_u32 v67, 5120, v66
    s_lshl_b32 s87, s68, 11
    s_add_u32 s95, s87, 153600
    s_mov_b32 s64, s18
    s_mov_b32 s65, s19
    s_cmp_eq_u32 s68, 0
    s_cselect_b32 s64, s6, s64
    s_cselect_b32 s65, s7, s65
    s_cmp_eq_u32 s68, 1
    s_cselect_b32 s64, s8, s64
    s_cselect_b32 s65, s9, s65
    s_mov_b32 s66, 1280
    s_mov_b32 s67, 0x00020000
    s_min_u32 s87, s68, 2
    s_lshl_b32 s87, s87, 8
    s_add_u32 m0, s87, 162048
    s_nop 0
    buffer_load_dword v74, s[64:67], 0 offen lds
    v_and_b32 v19, 15, v1
    v_lshrrev_b32 v20, 4, v1
    v_lshrrev_b32 v21, 2, v19
    v_lshlrev_b32 v21, 4, v21
    v_and_b32 v22, 3, v19
    v_add_u32 v21, v21, v22
    s_lshl_b32 s87, s69, 6
    v_add_u32 v21, s87, v21
    v_lshlrev_b32 v21, 7, v21
    v_and_b32 v22, 2, v19
    v_lshrrev_b32 v23, 3, v19
    v_lshl_or_b32 v22, v23, 2, v22
    v_xor_b32 v22, v22, v20
    v_lshl_add_u32 v12, v22, 4, v21
    v_xor_b32 v22, 4, v22
    v_lshl_add_u32 v13, v22, 4, v21
    v_lshrrev_b32 v21, 2, v19
    v_lshl_add_u32 v21, v20, 3, v21
    v_mul_u32_u24 v21, 192, v21
    v_and_b32 v22, 3, v19
    v_lshl_add_u32 v21, v22, 3, v21
    v_and_b32 v22, 1, v20
    v_lshl_add_u32 v14, v22, 5, v21
    v_xor_b32 v22, 1, v22
    v_lshl_add_u32 v15, v22, 5, v21
    s_cmp_eq_u32 s70, 1
    s_cselect_b64 vcc, -1, 0
    v_cndmask_b32 v16, v14, v15, vcc
    v_add_u32 v16, 64, v16
    s_lshl_b32 s87, s70, 7
    v_add_u32 v14, s87, v14
    v_add_u32 v15, s87, v15
    v_and_b32 v21, 1, v19
    v_lshrrev_b32 v22, 2, v19
    v_lshl_add_u32 v22, v22, 1, v21
    v_xor_b32 v22, v22, v20
    v_mul_u32_u24 v21, 40, v21
    v_lshrrev_b32 v23, 1, v19
    v_add_u32 v21, v21, v23
    v_lshlrev_b32 v21, 7, v21
    s_lshl_b32 s87, s70, 11
    v_add_u32 v21, s87, v21
    v_lshl_add_u32 v17, v22, 4, v21
    v_xor_b32 v22, 4, v22
    v_lshl_add_u32 v18, v22, 4, v21
    s_lshl_b32 s87, s69, 2
    v_add_u32 v50, s87, v20
    v_and_b32 v21, 1, v1
    v_cvt_f32_u32 v21, v21
    v_fma_f32 v48, v21, 2.0, -1.0
    v_lshrrev_b32 v21, 2, v19
    v_lshl_add_u32 v21, v20, 2, v21
    v_lshlrev_b32 v21, 6, v21
    v_and_b32 v22, 3, v19
    v_lshl_add_u32 v21, v22, 3, v21
    v_add_u32 v68, s95, v21
    v_lshlrev_b32 v90, 2, v19
    s_lshl_b32 s87, s70, 7
    v_add_u32 v97, s87, v90
    v_add_u32 v98, 153600, v90
    v_add_u32 v91, 153600, v97
    v_lshl_add_u32 v91, v50, 8, v91
    v_lshlrev_b32 v92, 1, v50
    v_add_u32 v92, s70, v92
    v_lshl_add_u32 v92, v92, 6, v98
    s_mul_i32 s87, s68, 320
    s_add_u32 s87, s87, 153600
    v_add_u32 v93, s87, v97
    v_lshlrev_b32 v51, 4, v1
    s_mul_i32 s87, s91, 360448
    v_add_u32 v116, s87, v51
    v_add_u32 v117, 90112, v116
    v_add_u32 v118, 180224, v116
    v_add_u32 v119, 270336, v116
    s_add_u32 s78, s78, 128
    s_cmp_eq_u32 s78, 1280
    s_cselect_b32 s78, 0, s78
    s_mul_i32 s79, s78, 1536
    s_add_u32 s81, s81, 128
    s_cmp_eq_u32 s81, 1280
    s_cselect_b32 s81, 0, s81
    s_mul_i32 s80, s81, 1536
    s_add_u32 m0, s82, 51200
    s_nop 0
    buffer_load_dwordx4 v2, s[40:43], s78 offen lds
    s_mul_i32 s87, s72, 10240
    buffer_load_dwordx4 v3, s[40:43], s78 offen offset:1024 lds
    s_add_u32 s87, s87, 11599872
    v_mul_u32_u24 v94, 640, v50
    buffer_load_dwordx4 v4, s[40:43], s78 offen offset:2048 lds
    v_lshl_add_u32 v94, v97, 1, v94
    v_add_u32 v94, s87, v94
    buffer_load_dwordx4 v5, s[40:43], s78 offen offset:3072 lds
    v_add_u32 v95, 5120, v94
    v_lshlrev_b32 v19, 1, v50
    s_add_u32 m0, s83, 51200
    s_nop 0
    buffer_load_dwordx4 v6, s[44:47], s79 offen lds
    v_add_u32 v19, s70, v19
    v_mul_u32_u24 v96, 640, v19
    buffer_load_dwordx4 v7, s[44:47], s79 offen offset:1024 lds
    v_lshl_add_u32 v96, v90, 1, v96
    v_add_u32 v96, s87, v96
    buffer_load_dwordx4 v8, s[44:47], s79 offen offset:2048 lds
    v_add_u32 v96, 512, v96
    v_mov_b32 v23, 0x7f000000
    s_add_u32 m0, s84, 51200
    s_nop 0
    buffer_load_dwordx4 v6, s[48:51], s80 offen lds
    v_add_u32 v20, 8, v50
    v_cmp_le_u32 vcc, s71, v50
    s_nop 1
    v_cndmask_b32 v94, v94, v23, vcc
    buffer_load_dwordx4 v7, s[48:51], s80 offen offset:1024 lds
    v_cmp_le_u32 vcc, s71, v20
    s_nop 1
    v_cndmask_b32 v95, v95, v23, vcc
    buffer_load_dwordx4 v8, s[48:51], s80 offen offset:2048 lds
    v_cmp_le_u32 vcc, s71, v19
    s_nop 1
    v_cndmask_b32 v96, v96, v23, vcc
    v_mov_b32 v76, 0
    s_add_u32 m0, s85, 51200
    s_nop 0
    buffer_load_dwordx4 v9, s[52:55], s81 offen lds
    v_mov_b32 v77, 0
    v_mov_b32 v78, 0
    buffer_load_dwordx4 v10, s[56:59], s81 offen offset:1024 lds
    v_mov_b32 v79, 0
    s_nop 1
    s_add_u32 m0, s86, 51200
    s_nop 0
    buffer_load_dwordx4 v11, s[60:63], s81 offen lds
    v_mfma_f32_32x32x16_bf16 v[120:135], v[76:79], v[76:79], 0
    v_mfma_f32_32x32x16_bf16 v[136:151], v[76:79], v[76:79], 0
    s_mov_b32 s64, s28
    s_mov_b32 s65, s29
    s_mov_b32 s66, 1966080
    s_mov_b32 s67, 0x00020000
    s_cmp_lt_u32 s2, 240
    s_cselect_b32 s66, s66, 0
    s_mov_b32 m0, s95
    s_nop 0
    buffer_load_dwordx4 v61, s[64:67], 0 offen lds
    v_mfma_f32_32x32x16_bf16 v[152:167], v[76:79], v[76:79], 0
    v_mfma_f32_32x32x16_bf16 v[168:183], v[76:79], v[76:79], 0
    buffer_load_dwordx4 v62, s[64:67], 0 offen offset:1024 lds
    v_mfma_f32_32x32x16_bf16 v[184:199], v[76:79], v[76:79], 0
    v_mfma_f32_32x32x16_bf16 v[200:215], v[76:79], v[76:79], 0
    s_cmp_eq_u32 s76, 1
    s_cselect_b32 s64, s16, s14
    s_cselect_b32 s65, s17, s15
    s_mov_b32 s66, 819200
    s_cmp_lt_u32 s2, 200
    s_cselect_b32 s66, s66, 0
    buffer_load_dwordx4 v[100:103], v63, s[64:67], 0 offen
    v_mfma_f32_32x32x16_bf16 v[216:231], v[76:79], v[76:79], 0
    v_mfma_f32_32x32x16_bf16 v[232:247], v[76:79], v[76:79], 0
    buffer_load_dwordx4 v[104:107], v63, s[64:67], 0 offen offset:64
    v_mfma_f32_16x16x32_bf16 v[248:251], v[76:79], v[76:79], 0
    v_mfma_f32_16x16x32_bf16 v[252:255], v[76:79], v[76:79], 0
    s_add_u32 s78, s78, 128
    s_cmp_eq_u32 s78, 1280
    s_cselect_b32 s78, 0, s78
    s_mul_i32 s79, s78, 1536
    s_add_u32 s81, s81, 128
    s_cmp_eq_u32 s81, 1280
    s_cselect_b32 s81, 0, s81
    s_mul_i32 s80, s81, 1536
    s_mov_b32 s73, 102400
    s_mov_b32 s74, 0
    s_mov_b32 s75, 51200
    s_mov_b32 s76, 0
    s_mov_b32 s77, 0
    s_mov_b32 s90, 0x22
    s_waitcnt vmcnt(17)
    s_barrier
    s_cmp_eq_u32 s70, 1
    s_cbranch_scc1 L_pre1
L_pre0:
    ds_read_b128 a[0:3], v12 offset:0
    ds_read_b64_tr_b16 a[16:17], v14 offset:16384
    ds_read_b64_tr_b16 a[18:19], v14 offset:17152
    ds_read_b128 a[4:7], v12 offset:512
    ds_read_b128 a[8:11], v12 offset:1024
    ds_read_b128 a[12:15], v12 offset:1536
    ds_read_b64_tr_b16 a[20:21], v14 offset:28672
    ds_read_b64_tr_b16 a[22:23], v14 offset:29440
    ds_read_b64_tr_b16 a[24:25], v15 offset:16384
    ds_read_b64_tr_b16 a[26:27], v15 offset:17152
    ds_read_b64_tr_b16 a[28:29], v15 offset:28672
    ds_read_b64_tr_b16 a[30:31], v15 offset:29440
    ds_read_b64_tr_b16 a[32:33], v16 offset:16384
    ds_read_b64_tr_b16 a[34:35], v16 offset:17152
    ds_read_b64_tr_b16 a[36:37], v16 offset:28672
    ds_read_b64_tr_b16 a[38:39], v16 offset:29440
    ds_read_b128 a[40:43], v17 offset:40960
    ds_read_b128 a[44:47], v17 offset:41984
    ds_read_b128 a[48:51], v17 offset:45056
    v_add_u32 v12, 51200, v12
    v_add_u32 v17, 51200, v17
    ds_read_u16 v52, v69 offset:0
    s_add_u32 m0, s73, s82
    s_nop 0
    buffer_load_dwordx4 v2, s[40:43], s78 offen lds
    ds_read_u16 v53, v69 offset:16
    ds_read_u16 v54, v70 offset:0
    ds_read_u16 v55, v69 offset:256
    ds_read_u16 v56, v69 offset:272
    ds_read_u16 v57, v70 offset:256
    ds_read_u16 v58, v69 offset:512
    ds_read_u16 v59, v69 offset:528
    ds_read_u16 v60, v70 offset:512
    buffer_load_dwordx4 v3, s[40:43], s78 offen offset:1024 lds
    v_cvt_f32_u32 v71, v50
    v_mov_b32 v72, 0x42e00000
    s_mov_b32 s87, 0xc1800000
    v_fma_f32 v71, v71, s87, v72
    s_lshl_b32 s87, s70, 3
    s_sub_u32 s87, 8, s87
    v_cvt_f32_u32 v73, s87
    v_add_f32 v73, v73, v71
    s_waitcnt lgkmcnt(0)
    buffer_load_dwordx4 v4, s[40:43], s78 offen offset:2048 lds
    v_lshlrev_b32 v30, 16, v52
    v_lshlrev_b32 v31, 16, v53
    v_lshlrev_b32 v32, 16, v54
    v_lshlrev_b32 v33, 16, v55
    v_lshlrev_b32 v34, 16, v56
    v_lshlrev_b32 v35, 16, v57
    v_lshlrev_b32 v86, 16, v58
    v_lshlrev_b32 v87, 16, v59
    v_lshlrev_b32 v88, 16, v60
    v_mul_f32 v86, 0x3fb8aa3b, v86
    v_mul_f32 v87, 0x3fb8aa3b, v87
    v_mul_f32 v88, 0x3fb8aa3b, v88
    v_exp_f32 v86, v86
    v_exp_f32 v87, v87
    v_exp_f32 v88, v88
    v_cvt_pk_bf16_f32 v86, v86, v86
    v_cvt_pk_bf16_f32 v87, v87, v87
    v_cvt_pk_bf16_f32 v88, v88, v88
    v_lshlrev_b32 v86, 16, v86
    v_lshlrev_b32 v87, 16, v87
    v_lshlrev_b32 v88, 16, v88
    v_mul_f32 v24, v86, v30
    v_mul_f32 v25, v87, v31
    v_mul_f32 v26, v88, v32
    buffer_load_dwordx4 v5, s[40:43], s78 offen offset:3072 lds
    v_mul_f32 v27, v86, v33
    v_mul_f32 v28, v87, v34
    v_mul_f32 v29, v88, v35
    v_mul_f32 v24, 0x3fb8aa3b, v24
    v_mul_f32 v25, 0x3fb8aa3b, v25
    v_mul_f32 v26, 0x3fb8aa3b, v26
    v_mul_f32 v27, 0x3e22f983, v27
    v_mul_f32 v28, 0x3e22f983, v28
    v_mul_f32 v29, 0x3e22f983, v29
    v_exp_f32 v80, v24
    v_exp_f32 v82, v25
    v_exp_f32 v84, v26
    v_rndne_f32 v36, v27
    v_rndne_f32 v37, v28
    v_rndne_f32 v38, v29
    v_sub_f32 v81, v27, v36
    v_sub_f32 v83, v28, v37
    v_sub_f32 v85, v29, v38
    v_cos_f32 v36, v81
    v_cos_f32 v37, v83
    v_cos_f32 v38, v85
    v_sin_f32 v39, v81
    v_sin_f32 v40, v83
    v_sin_f32 v41, v85
    v_mul_f32 v36, v80, v36
    v_mul_f32 v37, v82, v37
    v_mul_f32 v38, v84, v38
    s_add_u32 m0, s73, s83
    s_nop 0
    buffer_load_dwordx4 v6, s[44:47], s79 offen lds
    v_mul_f32 v80, v48, v80
    v_mul_f32 v82, v48, v82
    v_mul_f32 v84, v48, v84
    v_mul_f32 v39, v80, v39
    v_mul_f32 v40, v82, v40
    v_mul_f32 v41, v84, v41
    v_mul_f32 v80, v71, v24
    v_mul_f32 v82, v71, v25
    v_mul_f32 v84, v73, v26
    v_mul_f32 v81, v71, v27
    v_mul_f32 v83, v71, v28
    v_mul_f32 v85, v73, v29
    v_exp_f32 v80, v80
    v_exp_f32 v82, v82
    v_exp_f32 v84, v84
    v_rndne_f32 v42, v81
    v_rndne_f32 v43, v83
    v_rndne_f32 v44, v85
    v_sub_f32 v81, v81, v42
    v_sub_f32 v83, v83, v43
    v_sub_f32 v85, v85, v44
    v_cos_f32 v42, v81
    v_cos_f32 v43, v83
    v_cos_f32 v44, v85
    buffer_load_dwordx4 v7, s[44:47], s79 offen offset:1024 lds
    v_sin_f32 v45, v81
    v_sin_f32 v46, v83
    v_sin_f32 v47, v85
    v_mul_f32 v42, v80, v42
    v_mul_f32 v43, v82, v43
    v_mul_f32 v44, v84, v44
    v_mul_f32 v80, v48, v80
    v_mul_f32 v82, v48, v82
    v_mul_f32 v84, v48, v84
    v_mul_f32 v45, v80, v45
    v_mul_f32 v46, v82, v46
    v_mul_f32 v47, v84, v47
    s_and_b32 s14, s91, 7
    s_mul_i32 s14, s14, 3200
    v_lshlrev_b32 v83, 7, v1
    v_add_u32 v83, s14, v83
    v_cmp_gt_u32 vcc, 25, v1
    v_mov_b32 v19, 0x7f000000
    s_nop 0
    v_cndmask_b32 v83, v19, v83, vcc
    buffer_load_dwordx4 v8, s[44:47], s79 offen offset:2048 lds
    s_mul_i32 s15, s92, 88
    s_mul_i32 s14, s68, 12
    s_add_u32 s14, s14, s15
    s_add_u32 s14, s14, 47
    s_mul_i32 s14, s14, 5120
    s_mul_i32 s16, s68, 5
    s_add_u32 s15, s15, s16
    s_mul_i32 s15, s15, 5120
    s_add_u32 s16, s15, 102400
    s_waitcnt vmcnt(7)
    ds_read_b64_tr_b16 v[108:109], v68 offset:0
    ds_read_b64_tr_b16 v[110:111], v68 offset:1024
    ds_read_b64_tr_b16 v[112:113], v68 offset:32
    ds_read_b64_tr_b16 v[114:115], v68 offset:1056
    s_mov_b32 s64, s36
    s_mov_b32 s65, s37
    s_mov_b32 s66, 16187392
    s_mov_b32 s67, 0x00020000
    s_cmp_lt_u32 s2, 200
    s_cselect_b32 s66, s66, 0
    buffer_store_dwordx4 v[100:103], v66, s[64:67], 0 offen sc1
    buffer_store_dwordx4 v[104:107], v67, s[64:67], 0 offen sc1
    v_lshlrev_b32 v19, 5, v0
    v_add_u32 v19, 153600, v19
    s_waitcnt lgkmcnt(0)
    s_mov_b32 s66, 16187392
    s_cmp_lt_u32 s2, 240
    s_cselect_b32 s66, s66, 0
    buffer_store_dwordx4 v[108:111], v64, s[64:67], 0 offen sc1
    buffer_store_dwordx4 v[112:115], v65, s[64:67], 0 offen sc1
    ds_write_b128 v19, v[76:79]
    ds_write_b128 v19, v[76:79] offset:16
    v_mov_b32 v20, 0
    global_load_dword v49, v20, s[34:35] sc1
    s_waitcnt lgkmcnt(0)
    .p2align 3
L_loop0:
    v_mfma_f32_16x16x32_bf16 v[120:123], a[16:19], a[0:3], v[120:123]
    ds_read_b128 a[52:55], v13 offset:0
    s_add_u32 m0, s73, s84
    v_mfma_f32_16x16x32_bf16 v[124:127], a[16:19], a[4:7], v[124:127]
    ds_read_b64_tr_b16 a[68:69], v14 offset:22528
    buffer_load_dwordx4 v6, s[48:51], s80 offen lds
    v_mfma_f32_16x16x32_bf16 v[128:131], a[16:19], a[8:11], v[128:131]
    ds_read_b64_tr_b16 a[70:71], v14 offset:23296
    s_add_u32 s78, s78, 128
    v_mfma_f32_16x16x32_bf16 v[132:135], a[16:19], a[12:15], v[132:135]
    ds_read_b128 a[56:59], v13 offset:512
    v_mfma_f32_16x16x32_bf16 v[136:139], a[20:23], a[0:3], v[136:139]
    ds_read_b128 a[60:63], v13 offset:1024
    v_mfma_f32_16x16x32_bf16 v[140:143], a[20:23], a[4:7], v[140:143]
    ds_read_b128 a[64:67], v13 offset:1536
    v_mfma_f32_16x16x32_bf16 v[144:147], a[20:23], a[8:11], v[144:147]
    ds_read_b64_tr_b16 a[72:73], v14 offset:34816
    buffer_load_dwordx4 v7, s[48:51], s80 offen offset:1024 lds
    v_mfma_f32_16x16x32_bf16 v[148:151], a[20:23], a[12:15], v[148:151]
    ds_read_b64_tr_b16 a[74:75], v14 offset:35584
    v_mfma_f32_16x16x32_bf16 v[152:155], a[24:27], a[0:3], v[152:155]
    ds_read_b64_tr_b16 a[76:77], v15 offset:22528
    v_mfma_f32_16x16x32_bf16 v[156:159], a[24:27], a[4:7], v[156:159]
    ds_read_b64_tr_b16 a[78:79], v15 offset:23296
    v_mfma_f32_16x16x32_bf16 v[160:163], a[24:27], a[8:11], v[160:163]
    ds_read_b64_tr_b16 a[80:81], v15 offset:34816
    v_mfma_f32_16x16x32_bf16 v[164:167], a[24:27], a[12:15], v[164:167]
    ds_read_b64_tr_b16 a[82:83], v15 offset:35584
    buffer_load_dwordx4 v8, s[48:51], s80 offen offset:2048 lds
    v_mfma_f32_16x16x32_bf16 v[168:171], a[28:31], a[0:3], v[168:171]
    ds_read_b64_tr_b16 a[84:85], v16 offset:22528
    v_mfma_f32_16x16x32_bf16 v[172:175], a[28:31], a[4:7], v[172:175]
    ds_read_b64_tr_b16 a[86:87], v16 offset:23296
    v_mfma_f32_16x16x32_bf16 v[176:179], a[28:31], a[8:11], v[176:179]
    ds_read_b64_tr_b16 a[88:89], v16 offset:34816
    v_mfma_f32_16x16x32_bf16 v[180:183], a[28:31], a[12:15], v[180:183]
    ds_read_b64_tr_b16 a[90:91], v16 offset:35584
    s_add_u32 m0, s73, s85
    v_mfma_f32_16x16x32_bf16 v[184:187], a[32:35], a[0:3], v[184:187]
    ds_read_b128 a[92:95], v18 offset:40960
    buffer_load_dwordx4 v9, s[52:55], s81 offen lds
    v_mfma_f32_16x16x32_bf16 v[188:191], a[32:35], a[4:7], v[188:191]
    ds_read_b128 a[96:99], v18 offset:41984
    v_mfma_f32_16x16x32_bf16 v[192:195], a[32:35], a[8:11], v[192:195]
    ds_read_b128 a[100:103], v18 offset:45056
    v_mfma_f32_16x16x32_bf16 v[196:199], a[32:35], a[12:15], v[196:199]
    s_cmp_eq_u32 s78, 1280
    s_cselect_b32 s78, 0, s78
    v_mfma_f32_16x16x32_bf16 v[200:203], a[36:39], a[0:3], v[200:203]
    s_mul_i32 s79, s78, 1536
    v_add_u32 v14, s75, v14
    v_mfma_f32_16x16x32_bf16 v[204:207], a[36:39], a[4:7], v[204:207]
    buffer_load_dwordx4 v10, s[56:59], s81 offen offset:1024 lds
    v_add_u32 v15, s75, v15
    v_mfma_f32_16x16x32_bf16 v[208:211], a[36:39], a[8:11], v[208:211]
    v_add_u32 v16, s75, v16
    v_add_u32 v13, s75, v13
    v_mfma_f32_16x16x32_bf16 v[212:215], a[36:39], a[12:15], v[212:215]
    v_add_u32 v18, s75, v18
    v_mfma_f32_16x16x32_bf16 v[216:219], a[0:3], a[40:43], v[216:219]
    s_mov_b32 s87, s74
    s_add_u32 s74, s74, s75
    v_mfma_f32_16x16x32_bf16 v[220:223], a[4:7], a[40:43], v[220:223]
    s_add_u32 m0, s73, s86
    s_add_u32 s76, s76, 1
    v_mfma_f32_16x16x32_bf16 v[224:227], a[8:11], a[40:43], v[224:227]
    buffer_load_dwordx4 v11, s[60:63], s81 offen lds
    v_mfma_f32_16x16x32_bf16 v[228:231], a[12:15], a[40:43], v[228:231]
    s_cmp_eq_u32 s76, 3
    s_cselect_b32 s76, 0, s76
    v_mfma_f32_16x16x32_bf16 v[232:235], a[0:3], a[44:47], v[232:235]
    s_cmp_eq_u32 s76, 2
    s_cselect_b32 s75, 153600, 0
    v_mfma_f32_16x16x32_bf16 v[236:239], a[4:7], a[44:47], v[236:239]
    s_sub_u32 s75, 51200, s75
    v_mfma_f32_16x16x32_bf16 v[240:243], a[8:11], a[44:47], v[240:243]
    v_mfma_f32_16x16x32_bf16 v[244:247], a[12:15], a[44:47], v[244:247]
    v_mfma_f32_16x16x32_bf16 v[248:251], a[0:3], a[48:51], v[248:251]
    v_mfma_f32_16x16x32_bf16 v[252:255], a[4:7], a[48:51], v[252:255]
    s_waitcnt vmcnt(13) lgkmcnt(0)
    s_barrier
    v_mfma_f32_16x16x32_bf16 v[120:123], a[68:71], a[52:55], v[120:123]
    ds_read_b128 a[0:3], v12 offset:0
    s_add_u32 m0, s87, s82
    v_mfma_f32_16x16x32_bf16 v[124:127], a[68:71], a[56:59], v[124:127]
    ds_read_b64_tr_b16 a[16:17], v14 offset:16384
    buffer_load_dwordx4 v2, s[40:43], s78 offen lds
    v_mfma_f32_16x16x32_bf16 v[128:131], a[68:71], a[60:63], v[128:131]
    ds_read_b64_tr_b16 a[18:19], v14 offset:17152
    s_add_u32 s81, s81, 128
    v_mfma_f32_16x16x32_bf16 v[132:135], a[68:71], a[64:67], v[132:135]
    ds_read_b128 a[4:7], v12 offset:512
    v_mfma_f32_16x16x32_bf16 v[136:139], a[72:75], a[52:55], v[136:139]
    ds_read_b128 a[8:11], v12 offset:1024
    v_mfma_f32_16x16x32_bf16 v[140:143], a[72:75], a[56:59], v[140:143]
    ds_read_b128 a[12:15], v12 offset:1536
    buffer_load_dwordx4 v3, s[40:43], s78 offen offset:1024 lds
    v_mfma_f32_16x16x32_bf16 v[144:147], a[72:75], a[60:63], v[144:147]
    ds_read_b64_tr_b16 a[20:21], v14 offset:28672
    v_mfma_f32_16x16x32_bf16 v[148:151], a[72:75], a[64:67], v[148:151]
    ds_read_b64_tr_b16 a[22:23], v14 offset:29440
    v_mfma_f32_16x16x32_bf16 v[152:155], a[76:79], a[52:55], v[152:155]
    ds_read_b64_tr_b16 a[24:25], v15 offset:16384
    v_mfma_f32_16x16x32_bf16 v[156:159], a[76:79], a[56:59], v[156:159]
    ds_read_b64_tr_b16 a[26:27], v15 offset:17152
    buffer_load_dwordx4 v4, s[40:43], s78 offen offset:2048 lds
    v_mfma_f32_16x16x32_bf16 v[160:163], a[76:79], a[60:63], v[160:163]
    ds_read_b64_tr_b16 a[28:29], v15 offset:28672
    v_mfma_f32_16x16x32_bf16 v[164:167], a[76:79], a[64:67], v[164:167]
    ds_read_b64_tr_b16 a[30:31], v15 offset:29440
    v_mfma_f32_16x16x32_bf16 v[168:171], a[80:83], a[52:55], v[168:171]
    ds_read_b64_tr_b16 a[32:33], v16 offset:16384
    v_mfma_f32_16x16x32_bf16 v[172:175], a[80:83], a[56:59], v[172:175]
    ds_read_b64_tr_b16 a[34:35], v16 offset:17152
    buffer_load_dwordx4 v5, s[40:43], s78 offen offset:3072 lds
    v_mfma_f32_16x16x32_bf16 v[176:179], a[80:83], a[60:63], v[176:179]
    ds_read_b64_tr_b16 a[36:37], v16 offset:28672
    v_mfma_f32_16x16x32_bf16 v[180:183], a[80:83], a[64:67], v[180:183]
    ds_read_b64_tr_b16 a[38:39], v16 offset:29440
    v_mfma_f32_16x16x32_bf16 v[184:187], a[84:87], a[52:55], v[184:187]
    ds_read_b128 a[40:43], v17 offset:40960
    v_mfma_f32_16x16x32_bf16 v[188:191], a[84:87], a[56:59], v[188:191]
    ds_read_b128 a[44:47], v17 offset:41984
    s_add_u32 m0, s87, s83
    v_mfma_f32_16x16x32_bf16 v[192:195], a[84:87], a[60:63], v[192:195]
    ds_read_b128 a[48:51], v17 offset:45056
    buffer_load_dwordx4 v6, s[44:47], s79 offen lds
    v_mfma_f32_16x16x32_bf16 v[196:199], a[84:87], a[64:67], v[196:199]
    s_cmp_eq_u32 s81, 1280
    s_cselect_b32 s81, 0, s81
    v_mfma_f32_16x16x32_bf16 v[200:203], a[88:91], a[52:55], v[200:203]
    s_mul_i32 s80, s81, 1536
    v_add_u32 v12, s75, v12
    v_mfma_f32_16x16x32_bf16 v[204:207], a[88:91], a[56:59], v[204:207]
    v_add_u32 v17, s75, v17
    s_mov_b32 s73, s87
    v_mfma_f32_16x16x32_bf16 v[208:211], a[88:91], a[60:63], v[208:211]
    buffer_load_dwordx4 v7, s[44:47], s79 offen offset:1024 lds
    v_mfma_f32_16x16x32_bf16 v[212:215], a[88:91], a[64:67], v[212:215]
    v_mfma_f32_16x16x32_bf16 v[216:219], a[52:55], a[92:95], v[216:219]
    v_mfma_f32_16x16x32_bf16 v[220:223], a[56:59], a[92:95], v[220:223]
    v_mfma_f32_16x16x32_bf16 v[224:227], a[60:63], a[92:95], v[224:227]
    buffer_load_dwordx4 v8, s[44:47], s79 offen offset:2048 lds
    v_mfma_f32_16x16x32_bf16 v[228:231], a[64:67], a[92:95], v[228:231]
    v_mfma_f32_16x16x32_bf16 v[232:235], a[52:55], a[96:99], v[232:235]
    v_mfma_f32_16x16x32_bf16 v[236:239], a[56:59], a[96:99], v[236:239]
    v_mfma_f32_16x16x32_bf16 v[240:243], a[60:63], a[96:99], v[240:243]
    v_mfma_f32_16x16x32_bf16 v[244:247], a[64:67], a[96:99], v[244:247]
    v_mfma_f32_16x16x32_bf16 v[248:251], a[52:55], a[100:103], v[248:251]
    s_bitcmp1_b32 s90, s77
    s_cbranch_scc1 L_blk0
L_blkr0:
    v_mfma_f32_16x16x32_bf16 v[252:255], a[56:59], a[100:103], v[252:255]
    s_add_u32 s77, s77, 1
    s_cmp_lt_u32 s77, 7
    s_waitcnt lgkmcnt(0)
    s_cbranch_scc1 L_loop0
    v_mfma_f32_16x16x32_bf16 v[120:123], a[16:19], a[0:3], v[120:123]
    ds_read_b128 a[52:55], v13 offset:0
    s_add_u32 m0, s73, s84
    v_mfma_f32_16x16x32_bf16 v[124:127], a[16:19], a[4:7], v[124:127]
    ds_read_b64_tr_b16 a[68:69], v14 offset:22528
    buffer_load_dwordx4 v6, s[48:51], s80 offen lds
    v_mfma_f32_16x16x32_bf16 v[128:131], a[16:19], a[8:11], v[128:131]
    ds_read_b64_tr_b16 a[70:71], v14 offset:23296
    v_mfma_f32_16x16x32_bf16 v[132:135], a[16:19], a[12:15], v[132:135]
    ds_read_b128 a[56:59], v13 offset:512
    v_mfma_f32_16x16x32_bf16 v[136:139], a[20:23], a[0:3], v[136:139]
    ds_read_b128 a[60:63], v13 offset:1024
    v_mfma_f32_16x16x32_bf16 v[140:143], a[20:23], a[4:7], v[140:143]
    ds_read_b128 a[64:67], v13 offset:1536
    v_mfma_f32_16x16x32_bf16 v[144:147], a[20:23], a[8:11], v[144:147]
    ds_read_b64_tr_b16 a[72:73], v14 offset:34816
    buffer_load_dwordx4 v7, s[48:51], s80 offen offset:1024 lds
    v_mfma_f32_16x16x32_bf16 v[148:151], a[20:23], a[12:15], v[148:151]
    ds_read_b64_tr_b16 a[74:75], v14 offset:35584
    v_mfma_f32_16x16x32_bf16 v[152:155], a[24:27], a[0:3], v[152:155]
    ds_read_b64_tr_b16 a[76:77], v15 offset:22528
    v_mfma_f32_16x16x32_bf16 v[156:159], a[24:27], a[4:7], v[156:159]
    ds_read_b64_tr_b16 a[78:79], v15 offset:23296
    v_mfma_f32_16x16x32_bf16 v[160:163], a[24:27], a[8:11], v[160:163]
    ds_read_b64_tr_b16 a[80:81], v15 offset:34816
    v_mfma_f32_16x16x32_bf16 v[164:167], a[24:27], a[12:15], v[164:167]
    ds_read_b64_tr_b16 a[82:83], v15 offset:35584
    buffer_load_dwordx4 v8, s[48:51], s80 offen offset:2048 lds
    v_mfma_f32_16x16x32_bf16 v[168:171], a[28:31], a[0:3], v[168:171]
    ds_read_b64_tr_b16 a[84:85], v16 offset:22528
    v_mfma_f32_16x16x32_bf16 v[172:175], a[28:31], a[4:7], v[172:175]
    ds_read_b64_tr_b16 a[86:87], v16 offset:23296
    v_mfma_f32_16x16x32_bf16 v[176:179], a[28:31], a[8:11], v[176:179]
    ds_read_b64_tr_b16 a[88:89], v16 offset:34816
    v_mfma_f32_16x16x32_bf16 v[180:183], a[28:31], a[12:15], v[180:183]
    ds_read_b64_tr_b16 a[90:91], v16 offset:35584
    s_add_u32 m0, s73, s85
    v_mfma_f32_16x16x32_bf16 v[184:187], a[32:35], a[0:3], v[184:187]
    ds_read_b128 a[92:95], v18 offset:40960
    buffer_load_dwordx4 v9, s[52:55], s81 offen lds
    v_mfma_f32_16x16x32_bf16 v[188:191], a[32:35], a[4:7], v[188:191]
    ds_read_b128 a[96:99], v18 offset:41984
    v_mfma_f32_16x16x32_bf16 v[192:195], a[32:35], a[8:11], v[192:195]
    ds_read_b128 a[100:103], v18 offset:45056
    v_mfma_f32_16x16x32_bf16 v[196:199], a[32:35], a[12:15], v[196:199]
    v_add_u32 v14, 51200, v14
    v_add_u32 v15, 51200, v15
    v_mfma_f32_16x16x32_bf16 v[200:203], a[36:39], a[0:3], v[200:203]
    v_add_u32 v16, 51200, v16
    v_add_u32 v13, 51200, v13
    v_mfma_f32_16x16x32_bf16 v[204:207], a[36:39], a[4:7], v[204:207]
    buffer_load_dwordx4 v10, s[56:59], s81 offen offset:1024 lds
    v_add_u32 v18, 51200, v18
    v_mfma_f32_16x16x32_bf16 v[208:211], a[36:39], a[8:11], v[208:211]
    v_mfma_f32_16x16x32_bf16 v[212:215], a[36:39], a[12:15], v[212:215]
    v_mfma_f32_16x16x32_bf16 v[216:219], a[0:3], a[40:43], v[216:219]
    v_mfma_f32_16x16x32_bf16 v[220:223], a[4:7], a[40:43], v[220:223]
    s_add_u32 m0, s73, s86
    v_mfma_f32_16x16x32_bf16 v[224:227], a[8:11], a[40:43], v[224:227]
    buffer_load_dwordx4 v11, s[60:63], s81 offen lds
    v_mfma_f32_16x16x32_bf16 v[228:231], a[12:15], a[40:43], v[228:231]
    v_mfma_f32_16x16x32_bf16 v[232:235], a[0:3], a[44:47], v[232:235]
    v_mfma_f32_16x16x32_bf16 v[236:239], a[4:7], a[44:47], v[236:239]
    v_mfma_f32_16x16x32_bf16 v[240:243], a[8:11], a[44:47], v[240:243]
    v_mfma_f32_16x16x32_bf16 v[244:247], a[12:15], a[44:47], v[244:247]
    v_mfma_f32_16x16x32_bf16 v[248:251], a[0:3], a[48:51], v[248:251]
    v_mfma_f32_16x16x32_bf16 v[252:255], a[4:7], a[48:51], v[252:255]
    s_waitcnt vmcnt(13) lgkmcnt(0)
    s_barrier
    s_mov_b32 s95, 0
L_pf0:
    v_cmp_ne_u32 vcc, s3, v52
    v_cmp_ne_u32 s[38:39], s3, v53
    s_or_b64 vcc, vcc, s[38:39]
    v_cmp_ne_u32 s[38:39], s3, v54
    s_or_b64 vcc, vcc, s[38:39]
    v_cmp_ne_u32 s[38:39], s3, v55
    s_or_b64 vcc, vcc, s[38:39]
    s_cmp_eq_u64 vcc, 0
    s_cbranch_scc1 L_pfok0
    s_add_u32 s95, s95, 1
    s_cmp_gt_u32 s95, 100000
    s_cbranch_scc1 L_pfok0
    v_lshlrev_b32 v19, 4, v1
    v_add_u32 v19, 11812864, v19
    global_load_dwordx4 v[52:55], v19, s[36:37] sc1
    s_waitcnt vmcnt(0)
    s_branch L_pf0
L_pfok0:
    s_add_u32 s40, s36, 12582912
    s_addc_u32 s41, s37, 0
    s_mov_b32 s42, 3604480
    s_mov_b32 s43, 0x00020000
    s_mul_i32 s78, s92, 88
    s_mul_i32 s87, s68, 12
    s_add_u32 s78, s78, s87
    s_add_u32 s78, s78, 40
    s_mul_i32 s78, s78, 5120
    s_add_u32 s79, s78, 4096
    v_mfma_f32_16x16x32_bf16 v[120:123], a[68:71], a[52:55], v[120:123]
    ds_read_b128 a[0:3], v12 offset:0
    v_mfma_f32_16x16x32_bf16 v[124:127], a[68:71], a[56:59], v[124:127]
    ds_read_b64_tr_b16 a[16:17], v14 offset:16384
    buffer_load_dwordx4 a[104:107], v51, s[40:43], s78 offen sc1
    v_mfma_f32_16x16x32_bf16 v[128:131], a[68:71], a[60:63], v[128:131]
    ds_read_b64_tr_b16 a[18:19], v14 offset:17152
    v_mfma_f32_16x16x32_bf16 v[132:135], a[68:71], a[64:67], v[132:135]
    ds_read_b128 a[4:7], v12 offset:512
    v_mfma_f32_16x16x32_bf16 v[136:139], a[72:75], a[52:55], v[136:139]
    ds_read_b128 a[8:11], v12 offset:1024
    buffer_load_dwordx4 a[108:111], v51, s[40:43], s78 offen offset:1024 sc1
    v_mfma_f32_16x16x32_bf16 v[140:143], a[72:75], a[56:59], v[140:143]
    ds_read_b128 a[12:15], v12 offset:1536
    v_mfma_f32_16x16x32_bf16 v[144:147], a[72:75], a[60:63], v[144:147]
    ds_read_b64_tr_b16 a[20:21], v14 offset:28672
    v_mfma_f32_16x16x32_bf16 v[148:151], a[72:75], a[64:67], v[148:151]
    ds_read_b64_tr_b16 a[22:23], v14 offset:29440
    v_mfma_f32_16x16x32_bf16 v[152:155], a[76:79], a[52:55], v[152:155]
    ds_read_b64_tr_b16 a[24:25], v15 offset:16384
    buffer_load_dwordx4 a[112:115], v51, s[40:43], s78 offen offset:2048 sc1
    v_mfma_f32_16x16x32_bf16 v[156:159], a[76:79], a[56:59], v[156:159]
    ds_read_b64_tr_b16 a[26:27], v15 offset:17152
    v_mfma_f32_16x16x32_bf16 v[160:163], a[76:79], a[60:63], v[160:163]
    ds_read_b64_tr_b16 a[28:29], v15 offset:28672
    v_mfma_f32_16x16x32_bf16 v[164:167], a[76:79], a[64:67], v[164:167]
    ds_read_b64_tr_b16 a[30:31], v15 offset:29440
    v_mfma_f32_16x16x32_bf16 v[168:171], a[80:83], a[52:55], v[168:171]
    ds_read_b64_tr_b16 a[32:33], v16 offset:16384
    buffer_load_dwordx4 a[116:119], v51, s[40:43], s78 offen offset:3072 sc1
    v_mfma_f32_16x16x32_bf16 v[172:175], a[80:83], a[56:59], v[172:175]
    ds_read_b64_tr_b16 a[34:35], v16 offset:17152
    v_mfma_f32_16x16x32_bf16 v[176:179], a[80:83], a[60:63], v[176:179]
    ds_read_b64_tr_b16 a[36:37], v16 offset:28672
    v_mfma_f32_16x16x32_bf16 v[180:183], a[80:83], a[64:67], v[180:183]
    ds_read_b64_tr_b16 a[38:39], v16 offset:29440
    v_mfma_f32_16x16x32_bf16 v[184:187], a[84:87], a[52:55], v[184:187]
    ds_read_b128 a[40:43], v17 offset:40960
    buffer_load_dwordx4 a[120:123], v51, s[40:43], s79 offen sc1
    v_mfma_f32_16x16x32_bf16 v[188:191], a[84:87], a[56:59], v[188:191]
    ds_read_b128 a[44:47], v17 offset:41984
    s_add_u32 s78, s78, 5120
    v_mfma_f32_16x16x32_bf16 v[192:195], a[84:87], a[60:63], v[192:195]
    ds_read_b128 a[48:51], v17 offset:45056
    s_add_u32 s79, s79, 5120
    v_mfma_f32_16x16x32_bf16 v[196:199], a[84:87], a[64:67], v[196:199]
    buffer_load_dwordx4 a[124:127], v51, s[40:43], s78 offen sc1
    v_add_u32 v12, 0xfffe7000, v12
    v_mfma_f32_16x16x32_bf16 v[200:203], a[88:91], a[52:55], v[200:203]
    v_add_u32 v17, 0xfffe7000, v17
    v_mfma_f32_16x16x32_bf16 v[204:207], a[88:91], a[56:59], v[204:207]
    v_mov_b32 v73, 0
    v_mov_b32 v74, 0
    v_mfma_f32_16x16x32_bf16 v[208:211], a[88:91], a[60:63], v[208:211]
    v_lshlrev_b32 v75, 16, v56
    v_and_b32 v76, 0xffff0000, v56
    v_mfma_f32_16x16x32_bf16 v[212:215], a[88:91], a[64:67], v[212:215]
    buffer_load_dwordx4 a[128:131], v51, s[40:43], s78 offen offset:1024 sc1
    v_mfma_f32_16x16x32_bf16 v[216:219], a[52:55], a[92:95], v[216:219]
    v_lshlrev_b32 v77, 16, v62
    v_and_b32 v78, 0xffff0000, v62
    v_mfma_f32_16x16x32_bf16 v[220:223], a[56:59], a[92:95], v[220:223]
    v_mul_f32 v77, v77, v75
    v_mul_f32 v78, v78, v76
    v_mfma_f32_16x16x32_bf16 v[224:227], a[60:63], a[92:95], v[224:227]
    v_cvt_pk_bf16_f32 v77, v77, v78
    v_and_b32 v78, 0xffff0000, v77
    v_mfma_f32_16x16x32_bf16 v[228:231], a[64:67], a[92:95], v[228:231]
    buffer_load_dwordx4 a[132:135], v51, s[40:43], s78 offen offset:2048 sc1
    v_mfma_f32_16x16x32_bf16 v[232:235], a[52:55], a[96:99], v[232:235]
    v_lshlrev_b32 v77, 16, v77
    v_add_f32 v73, v73, v77
    v_mfma_f32_16x16x32_bf16 v[236:239], a[56:59], a[96:99], v[236:239]
    v_add_f32 v73, v73, v78
    v_lshlrev_b32 v77, 16, v66
    v_mfma_f32_16x16x32_bf16 v[240:243], a[60:63], a[96:99], v[240:243]
    v_and_b32 v78, 0xffff0000, v66
    v_mul_f32 v77, v77, v75
    v_mfma_f32_16x16x32_bf16 v[244:247], a[64:67], a[96:99], v[244:247]
    v_mul_f32 v78, v78, v76
    v_cvt_pk_bf16_f32 v77, v77, v78
    v_mfma_f32_16x16x32_bf16 v[248:251], a[52:55], a[100:103], v[248:251]
    v_and_b32 v78, 0xffff0000, v77
    v_lshlrev_b32 v77, 16, v77
    v_mfma_f32_16x16x32_bf16 v[252:255], a[56:59], a[100:103], v[252:255]
    v_add_f32 v74, v74, v77
    v_add_f32 v74, v74, v78
    s_waitcnt lgkmcnt(0)
    v_mfma_f32_16x16x32_bf16 v[120:123], a[16:19], a[0:3], v[120:123]
    ds_read_b128 a[52:55], v13 offset:0
    v_mfma_f32_16x16x32_bf16 v[124:127], a[16:19], a[4:7], v[124:127]
    ds_read_b64_tr_b16 a[68:69], v14 offset:22528
    buffer_load_dwordx4 a[136:139], v51, s[40:43], s78 offen offset:3072 sc1
    v_mfma_f32_16x16x32_bf16 v[128:131], a[16:19], a[8:11], v[128:131]
    ds_read_b64_tr_b16 a[70:71], v14 offset:23296
    v_mfma_f32_16x16x32_bf16 v[132:135], a[16:19], a[12:15], v[132:135]
    ds_read_b128 a[56:59], v13 offset:512
    v_mfma_f32_16x16x32_bf16 v[136:139], a[20:23], a[0:3], v[136:139]
    ds_read_b128 a[60:63], v13 offset:1024
    buffer_load_dwordx4 a[140:143], v51, s[40:43], s79 offen sc1
    v_mfma_f32_16x16x32_bf16 v[140:143], a[20:23], a[4:7], v[140:143]
    ds_read_b128 a[64:67], v13 offset:1536
    v_mfma_f32_16x16x32_bf16 v[144:147], a[20:23], a[8:11], v[144:147]
    ds_read_b64_tr_b16 a[72:73], v14 offset:34816
    s_add_u32 s78, s78, 5120
    v_mfma_f32_16x16x32_bf16 v[148:151], a[20:23], a[12:15], v[148:151]
    ds_read_b64_tr_b16 a[74:75], v14 offset:35584
    s_add_u32 s79, s79, 5120
    v_mfma_f32_16x16x32_bf16 v[152:155], a[24:27], a[0:3], v[152:155]
    ds_read_b64_tr_b16 a[76:77], v15 offset:22528
    buffer_load_dwordx4 a[144:147], v51, s[40:43], s78 offen sc1
    v_mfma_f32_16x16x32_bf16 v[156:159], a[24:27], a[4:7], v[156:159]
    ds_read_b64_tr_b16 a[78:79], v15 offset:23296
    v_mfma_f32_16x16x32_bf16 v[160:163], a[24:27], a[8:11], v[160:163]
    ds_read_b64_tr_b16 a[80:81], v15 offset:34816
    v_mfma_f32_16x16x32_bf16 v[164:167], a[24:27], a[12:15], v[164:167]
    ds_read_b64_tr_b16 a[82:83], v15 offset:35584
    v_mfma_f32_16x16x32_bf16 v[168:171], a[28:31], a[0:3], v[168:171]
    ds_read_b64_tr_b16 a[84:85], v16 offset:22528
    buffer_load_dwordx4 a[148:151], v51, s[40:43], s78 offen offset:1024 sc1
    v_mfma_f32_16x16x32_bf16 v[172:175], a[28:31], a[4:7], v[172:175]
    ds_read_b64_tr_b16 a[86:87], v16 offset:23296
    v_mfma_f32_16x16x32_bf16 v[176:179], a[28:31], a[8:11], v[176:179]
    ds_read_b64_tr_b16 a[88:89], v16 offset:34816
    v_mfma_f32_16x16x32_bf16 v[180:183], a[28:31], a[12:15], v[180:183]
    ds_read_b64_tr_b16 a[90:91], v16 offset:35584
    v_mfma_f32_16x16x32_bf16 v[184:187], a[32:35], a[0:3], v[184:187]
    ds_read_b128 a[92:95], v18 offset:40960
    buffer_load_dwordx4 a[152:155], v51, s[40:43], s78 offen offset:2048 sc1
    v_mfma_f32_16x16x32_bf16 v[188:191], a[32:35], a[4:7], v[188:191]
    ds_read_b128 a[96:99], v18 offset:41984
    v_mfma_f32_16x16x32_bf16 v[192:195], a[32:35], a[8:11], v[192:195]
    ds_read_b128 a[100:103], v18 offset:45056
    v_mfma_f32_16x16x32_bf16 v[196:199], a[32:35], a[12:15], v[196:199]
    buffer_load_dwordx4 a[156:159], v51, s[40:43], s78 offen offset:3072 sc1
    v_add_u32 v14, 0xfffe7000, v14
    v_mfma_f32_16x16x32_bf16 v[200:203], a[36:39], a[0:3], v[200:203]
    v_add_u32 v15, 0xfffe7000, v15
    v_add_u32 v16, 0xfffe7000, v16
    v_mfma_f32_16x16x32_bf16 v[204:207], a[36:39], a[4:7], v[204:207]
    v_add_u32 v13, 0xfffe7000, v13
    v_add_u32 v18, 0xfffe7000, v18
    v_mfma_f32_16x16x32_bf16 v[208:211], a[36:39], a[8:11], v[208:211]
    v_lshlrev_b32 v75, 16, v57
    v_and_b32 v76, 0xffff0000, v57
    v_mfma_f32_16x16x32_bf16 v[212:215], a[36:39], a[12:15], v[212:215]
    buffer_load_dwordx4 a[160:163], v51, s[40:43], s79 offen sc1
    v_mfma_f32_16x16x32_bf16 v[216:219], a[0:3], a[40:43], v[216:219]
    v_lshlrev_b32 v77, 16, v63
    v_and_b32 v78, 0xffff0000, v63
    v_mfma_f32_16x16x32_bf16 v[220:223], a[4:7], a[40:43], v[220:223]
    v_mul_f32 v77, v77, v75
    v_mul_f32 v78, v78, v76
    v_mfma_f32_16x16x32_bf16 v[224:227], a[8:11], a[40:43], v[224:227]
    s_add_u32 s79, s79, 5120
    s_add_u32 s78, s78, 5120
    v_mfma_f32_16x16x32_bf16 v[228:231], a[12:15], a[40:43], v[228:231]
    buffer_load_dwordx4 a[164:167], v51, s[40:43], s78 offen sc1
    v_mfma_f32_16x16x32_bf16 v[232:235], a[0:3], a[44:47], v[232:235]
    v_cvt_pk_bf16_f32 v77, v77, v78
    v_and_b32 v78, 0xffff0000, v77
    v_mfma_f32_16x16x32_bf16 v[236:239], a[4:7], a[44:47], v[236:239]
    v_lshlrev_b32 v77, 16, v77
    v_add_f32 v73, v73, v77
    v_mfma_f32_16x16x32_bf16 v[240:243], a[8:11], a[44:47], v[240:243]
    v_add_f32 v73, v73, v78
    v_lshlrev_b32 v77, 16, v67
    v_mfma_f32_16x16x32_bf16 v[244:247], a[12:15], a[44:47], v[244:247]
    v_and_b32 v78, 0xffff0000, v67
    v_mul_f32 v77, v77, v75
    v_mfma_f32_16x16x32_bf16 v[248:251], a[0:3], a[48:51], v[248:251]
    v_mul_f32 v78, v78, v76
    v_cvt_pk_bf16_f32 v77, v77, v78
    v_mfma_f32_16x16x32_bf16 v[252:255], a[4:7], a[48:51], v[252:255]
    v_and_b32 v78, 0xffff0000, v77
    v_lshlrev_b32 v77, 16, v77
    s_waitcnt vmcnt(16) lgkmcnt(0)
    s_barrier
    v_mfma_f32_16x16x32_bf16 v[120:123], a[68:71], a[52:55], v[120:123]
    ds_read_b128 a[0:3], v12 offset:0
    v_mfma_f32_16x16x32_bf16 v[124:127], a[68:71], a[56:59], v[124:127]
    ds_read_b64_tr_b16 a[16:17], v14 offset:16384
    buffer_load_dwordx4 a[168:171], v51, s[40:43], s78 offen offset:1024 sc1
    v_mfma_f32_16x16x32_bf16 v[128:131], a[68:71], a[60:63], v[128:131]
    ds_read_b64_tr_b16 a[18:19], v14 offset:17152
    v_mfma_f32_16x16x32_bf16 v[132:135], a[68:71], a[64:67], v[132:135]
    ds_read_b128 a[4:7], v12 offset:512
    v_mfma_f32_16x16x32_bf16 v[136:139], a[72:75], a[52:55], v[136:139]
    ds_read_b128 a[8:11], v12 offset:1024
    buffer_load_dwordx4 a[172:175], v51, s[40:43], s78 offen offset:2048 sc1
    v_mfma_f32_16x16x32_bf16 v[140:143], a[72:75], a[56:59], v[140:143]
    ds_read_b128 a[12:15], v12 offset:1536
    v_mfma_f32_16x16x32_bf16 v[144:147], a[72:75], a[60:63], v[144:147]
    ds_read_b64_tr_b16 a[20:21], v14 offset:28672
    v_mfma_f32_16x16x32_bf16 v[148:151], a[72:75], a[64:67], v[148:151]
    ds_read_b64_tr_b16 a[22:23], v14 offset:29440
    v_mfma_f32_16x16x32_bf16 v[152:155], a[76:79], a[52:55], v[152:155]
    ds_read_b64_tr_b16 a[24:25], v15 offset:16384
    buffer_load_dwordx4 a[176:179], v51, s[40:43], s78 offen offset:3072 sc1
    v_mfma_f32_16x16x32_bf16 v[156:159], a[76:79], a[56:59], v[156:159]
    ds_read_b64_tr_b16 a[26:27], v15 offset:17152
    v_mfma_f32_16x16x32_bf16 v[160:163], a[76:79], a[60:63], v[160:163]
    ds_read_b64_tr_b16 a[28:29], v15 offset:28672
    v_mfma_f32_16x16x32_bf16 v[164:167], a[76:79], a[64:67], v[164:167]
    ds_read_b64_tr_b16 a[30:31], v15 offset:29440
    v_mfma_f32_16x16x32_bf16 v[168:171], a[80:83], a[52:55], v[168:171]
    ds_read_b64_tr_b16 a[32:33], v16 offset:16384
    buffer_load_dwordx4 a[180:183], v51, s[40:43], s79 offen sc1
    v_mfma_f32_16x16x32_bf16 v[172:175], a[80:83], a[56:59], v[172:175]
    ds_read_b64_tr_b16 a[34:35], v16 offset:17152
    v_mfma_f32_16x16x32_bf16 v[176:179], a[80:83], a[60:63], v[176:179]
    ds_read_b64_tr_b16 a[36:37], v16 offset:28672
    s_add_u32 s78, s78, 5120
    v_mfma_f32_16x16x32_bf16 v[180:183], a[80:83], a[64:67], v[180:183]
    ds_read_b64_tr_b16 a[38:39], v16 offset:29440
    s_add_u32 s79, s79, 5120
    v_mfma_f32_16x16x32_bf16 v[184:187], a[84:87], a[52:55], v[184:187]
    ds_read_b128 a[40:43], v17 offset:40960
    buffer_load_dwordx4 a[184:187], v51, s[40:43], s78 offen sc1
    v_mfma_f32_16x16x32_bf16 v[188:191], a[84:87], a[56:59], v[188:191]
    ds_read_b128 a[44:47], v17 offset:41984
    v_mfma_f32_16x16x32_bf16 v[192:195], a[84:87], a[60:63], v[192:195]
    ds_read_b128 a[48:51], v17 offset:45056
    v_mfma_f32_16x16x32_bf16 v[196:199], a[84:87], a[64:67], v[196:199]
    buffer_load_dwordx4 a[188:191], v51, s[40:43], s78 offen offset:1024 sc1
    v_mfma_f32_16x16x32_bf16 v[200:203], a[88:91], a[52:55], v[200:203]
    v_add_f32 v74, v74, v77
    v_add_f32 v74, v74, v78
    v_mfma_f32_16x16x32_bf16 v[204:207], a[88:91], a[56:59], v[204:207]
    v_lshlrev_b32 v75, 16, v58
    v_and_b32 v76, 0xffff0000, v58
    v_mfma_f32_16x16x32_bf16 v[208:211], a[88:91], a[60:63], v[208:211]
    v_lshlrev_b32 v77, 16, v64
    v_and_b32 v78, 0xffff0000, v64
    v_mfma_f32_16x16x32_bf16 v[212:215], a[88:91], a[64:67], v[212:215]
    buffer_load_dwordx4 a[192:195], v51, s[40:43], s78 offen offset:2048 sc1
    v_mfma_f32_16x16x32_bf16 v[216:219], a[52:55], a[92:95], v[216:219]
    v_mul_f32 v77, v77, v75
    v_mul_f32 v78, v78, v76
    v_mfma_f32_16x16x32_bf16 v[220:223], a[56:59], a[92:95], v[220:223]
    v_cvt_pk_bf16_f32 v77, v77, v78
    v_and_b32 v78, 0xffff0000, v77
    v_mfma_f32_16x16x32_bf16 v[224:227], a[60:63], a[92:95], v[224:227]
    v_lshlrev_b32 v77, 16, v77
    v_add_f32 v73, v73, v77
    v_mfma_f32_16x16x32_bf16 v[228:231], a[64:67], a[92:95], v[228:231]
    buffer_load_dwordx4 a[196:199], v51, s[40:43], s78 offen offset:3072 sc1
    v_mfma_f32_16x16x32_bf16 v[232:235], a[52:55], a[96:99], v[232:235]
    v_add_f32 v73, v73, v78
    v_lshlrev_b32 v77, 16, v68
    v_mfma_f32_16x16x32_bf16 v[236:239], a[56:59], a[96:99], v[236:239]
    v_and_b32 v78, 0xffff0000, v68
    v_mul_f32 v77, v77, v75
    v_mfma_f32_16x16x32_bf16 v[240:243], a[60:63], a[96:99], v[240:243]
    v_mul_f32 v78, v78, v76
    v_cvt_pk_bf16_f32 v77, v77, v78
    v_mfma_f32_16x16x32_bf16 v[244:247], a[64:67], a[96:99], v[244:247]
    v_and_b32 v78, 0xffff0000, v77
    v_lshlrev_b32 v77, 16, v77
    v_mfma_f32_16x16x32_bf16 v[248:251], a[52:55], a[100:103], v[248:251]
    v_add_f32 v74, v74, v77
    v_add_f32 v74, v74, v78
    v_mfma_f32_16x16x32_bf16 v[252:255], a[56:59], a[100:103], v[252:255]
    v_lshlrev_b32 v75, 16, v59
    v_and_b32 v76, 0xffff0000, v59
    s_waitcnt lgkmcnt(0)
    v_mfma_f32_16x16x32_bf16 v[120:123], a[16:19], a[0:3], v[120:123]
    ds_read_b128 a[52:55], v13 offset:0
    v_mfma_f32_16x16x32_bf16 v[124:127], a[16:19], a[4:7], v[124:127]
    ds_read_b64_tr_b16 a[68:69], v14 offset:22528
    buffer_load_dwordx4 a[200:203], v51, s[40:43], s79 offen sc1
    v_mfma_f32_16x16x32_bf16 v[128:131], a[16:19], a[8:11], v[128:131]
    ds_read_b64_tr_b16 a[70:71], v14 offset:23296
    s_add_u32 s78, s78, 5120
    v_mfma_f32_16x16x32_bf16 v[132:135], a[16:19], a[12:15], v[132:135]
    ds_read_b128 a[56:59], v13 offset:512
    s_add_u32 s79, s79, 5120
    v_mfma_f32_16x16x32_bf16 v[136:139], a[20:23], a[0:3], v[136:139]
    ds_read_b128 a[60:63], v13 offset:1024
    buffer_load_dwordx4 a[204:207], v51, s[40:43], s78 offen sc1
    v_mfma_f32_16x16x32_bf16 v[140:143], a[20:23], a[4:7], v[140:143]
    ds_read_b128 a[64:67], v13 offset:1536
    v_mfma_f32_16x16x32_bf16 v[144:147], a[20:23], a[8:11], v[144:147]
    ds_read_b64_tr_b16 a[72:73], v14 offset:34816
    v_mfma_f32_16x16x32_bf16 v[148:151], a[20:23], a[12:15], v[148:151]
    ds_read_b64_tr_b16 a[74:75], v14 offset:35584
    buffer_load_dwordx4 a[208:211], v51, s[40:43], s78 offen offset:1024 sc1
    v_mfma_f32_16x16x32_bf16 v[152:155], a[24:27], a[0:3], v[152:155]
    ds_read_b64_tr_b16 a[76:77], v15 offset:22528
    v_mfma_f32_16x16x32_bf16 v[156:159], a[24:27], a[4:7], v[156:159]
    ds_read_b64_tr_b16 a[78:79], v15 offset:23296
    v_mfma_f32_16x16x32_bf16 v[160:163], a[24:27], a[8:11], v[160:163]
    ds_read_b64_tr_b16 a[80:81], v15 offset:34816
    v_mfma_f32_16x16x32_bf16 v[164:167], a[24:27], a[12:15], v[164:167]
    ds_read_b64_tr_b16 a[82:83], v15 offset:35584
    buffer_load_dwordx4 a[212:215], v51, s[40:43], s78 offen offset:2048 sc1
    v_mfma_f32_16x16x32_bf16 v[168:171], a[28:31], a[0:3], v[168:171]
    ds_read_b64_tr_b16 a[84:85], v16 offset:22528
    v_mfma_f32_16x16x32_bf16 v[172:175], a[28:31], a[4:7], v[172:175]
    ds_read_b64_tr_b16 a[86:87], v16 offset:23296
    v_mfma_f32_16x16x32_bf16 v[176:179], a[28:31], a[8:11], v[176:179]
    ds_read_b64_tr_b16 a[88:89], v16 offset:34816
    buffer_load_dwordx4 a[216:219], v51, s[40:43], s78 offen offset:3072 sc1
    v_mfma_f32_16x16x32_bf16 v[180:183], a[28:31], a[12:15], v[180:183]
    ds_read_b64_tr_b16 a[90:91], v16 offset:35584
    v_mfma_f32_16x16x32_bf16 v[184:187], a[32:35], a[0:3], v[184:187]
    ds_read_b128 a[92:95], v18 offset:40960
    v_mfma_f32_16x16x32_bf16 v[188:191], a[32:35], a[4:7], v[188:191]
    ds_read_b128 a[96:99], v18 offset:41984
    buffer_load_dwordx4 a[220:223], v51, s[40:43], s79 offen sc1
    v_mfma_f32_16x16x32_bf16 v[192:195], a[32:35], a[8:11], v[192:195]
    ds_read_b128 a[100:103], v18 offset:45056
    s_add_u32 s78, s78, 5120
    v_mfma_f32_16x16x32_bf16 v[196:199], a[32:35], a[12:15], v[196:199]
    s_add_u32 s79, s79, 5120
    v_mfma_f32_16x16x32_bf16 v[200:203], a[36:39], a[0:3], v[200:203]
    v_lshlrev_b32 v77, 16, v65
    v_and_b32 v78, 0xffff0000, v65
    v_mfma_f32_16x16x32_bf16 v[204:207], a[36:39], a[4:7], v[204:207]
    v_mul_f32 v77, v77, v75
    v_mul_f32 v78, v78, v76
    v_mfma_f32_16x16x32_bf16 v[208:211], a[36:39], a[8:11], v[208:211]
    v_cvt_pk_bf16_f32 v77, v77, v78
    v_and_b32 v78, 0xffff0000, v77
    v_mfma_f32_16x16x32_bf16 v[212:215], a[36:39], a[12:15], v[212:215]
    v_lshlrev_b32 v77, 16, v77
    v_add_f32 v73, v73, v77
    s_waitcnt lgkmcnt(0)
    v_mfma_f32_16x16x32_bf16 v[120:123], a[68:71], a[52:55], v[120:123]
    v_add_f32 v73, v73, v78
    v_lshlrev_b32 v77, 16, v69
    v_mfma_f32_16x16x32_bf16 v[124:127], a[68:71], a[56:59], v[124:127]
    buffer_load_dwordx4 a[224:227], v51, s[40:43], s78 offen sc1
    v_mfma_f32_16x16x32_bf16 v[128:131], a[68:71], a[60:63], v[128:131]
    v_and_b32 v78, 0xffff0000, v69
    v_mul_f32 v77, v77, v75
    v_mfma_f32_16x16x32_bf16 v[132:135], a[68:71], a[64:67], v[132:135]
    v_mul_f32 v78, v78, v76
    v_cvt_pk_bf16_f32 v77, v77, v78
    v_mfma_f32_16x16x32_bf16 v[136:139], a[72:75], a[52:55], v[136:139]
    v_and_b32 v78, 0xffff0000, v77
    v_lshlrev_b32 v77, 16, v77
    v_mfma_f32_16x16x32_bf16 v[140:143], a[72:75], a[56:59], v[140:143]
    buffer_load_dwordx4 a[228:231], v51, s[40:43], s78 offen offset:1024 sc1
    v_mfma_f32_16x16x32_bf16 v[144:147], a[72:75], a[60:63], v[144:147]
    v_add_f32 v74, v74, v77
    v_add_f32 v74, v74, v78
    v_mfma_f32_16x16x32_bf16 v[148:151], a[72:75], a[64:67], v[148:151]
    v_lshlrev_b32 v75, 16, v60
    v_and_b32 v76, 0xffff0000, v60
    v_mfma_f32_16x16x32_bf16 v[152:155], a[76:79], a[52:55], v[152:155]
    v_lshlrev_b32 v77, 16, v61
    v_and_b32 v78, 0xffff0000, v61
    v_mfma_f32_16x16x32_bf16 v[156:159], a[76:79], a[56:59], v[156:159]
    buffer_load_dwordx4 a[232:235], v51, s[40:43], s78 offen offset:2048 sc1
    v_mfma_f32_16x16x32_bf16 v[160:163], a[76:79], a[60:63], v[160:163]
    v_mul_f32 v77, v77, v75
    v_mul_f32 v78, v78, v76
    v_mfma_f32_16x16x32_bf16 v[164:167], a[76:79], a[64:67], v[164:167]
    v_cvt_pk_bf16_f32 v77, v77, v78
    v_and_b32 v78, 0xffff0000, v77
    v_mfma_f32_16x16x32_bf16 v[168:171], a[80:83], a[52:55], v[168:171]
    v_lshlrev_b32 v77, 16, v77
    v_add_f32 v73, v73, v77
    v_mfma_f32_16x16x32_bf16 v[172:175], a[80:83], a[56:59], v[172:175]
    buffer_load_dwordx4 a[236:239], v51, s[40:43], s78 offen offset:3072 sc1
    v_mfma_f32_16x16x32_bf16 v[176:179], a[80:83], a[60:63], v[176:179]
    v_add_f32 v73, v73, v78
    v_lshlrev_b32 v77, 16, v70
    v_mfma_f32_16x16x32_bf16 v[180:183], a[80:83], a[64:67], v[180:183]
    v_and_b32 v78, 0xffff0000, v70
    v_mul_f32 v77, v77, v75
    v_mfma_f32_16x16x32_bf16 v[184:187], a[84:87], a[52:55], v[184:187]
    v_mul_f32 v78, v78, v76
    v_cvt_pk_bf16_f32 v77, v77, v78
    v_mfma_f32_16x16x32_bf16 v[188:191], a[84:87], a[56:59], v[188:191]
    buffer_load_dwordx4 a[240:243], v51, s[40:43], s79 offen sc1
    v_mfma_f32_16x16x32_bf16 v[192:195], a[84:87], a[60:63], v[192:195]
    s_add_u32 s78, s78, 5120
    s_add_u32 s79, s79, 5120
    v_mfma_f32_16x16x32_bf16 v[196:199], a[84:87], a[64:67], v[196:199]
    v_and_b32 v78, 0xffff0000, v77
    v_lshlrev_b32 v77, 16, v77
    v_mfma_f32_16x16x32_bf16 v[200:203], a[88:91], a[52:55], v[200:203]
    v_add_f32 v74, v74, v77
    v_add_f32 v74, v74, v78
    v_mfma_f32_16x16x32_bf16 v[204:207], a[88:91], a[56:59], v[204:207]
    v_add_f32_dpp v73, v73, v73 row_shr:1 row_mask:0xf bank_mask:0xf bound_ctrl:0
    v_add_f32_dpp v74, v74, v74 row_shr:1 row_mask:0xf bank_mask:0xf bound_ctrl:0
    v_mfma_f32_16x16x32_bf16 v[208:211], a[88:91], a[60:63], v[208:211]
    v_add_f32_dpp v73, v73, v73 row_shr:2 row_mask:0xf bank_mask:0xf bound_ctrl:0
    v_add_f32_dpp v74, v74, v74 row_shr:2 row_mask:0xf bank_mask:0xf bound_ctrl:0
    v_mfma_f32_16x16x32_bf16 v[212:215], a[88:91], a[64:67], v[212:215]
    v_add_f32_dpp v73, v73, v73 row_shr:4 row_mask:0xf bank_mask:0xf bound_ctrl:0
    v_add_f32_dpp v74, v74, v74 row_shr:4 row_mask:0xf bank_mask:0xf bound_ctrl:0
    s_lshl_b32 s87, s71, 1
    s_add_u32 s87, s87, s69
    s_mul_i32 s87, s87, 352
    s_mul_i32 s88, s72, 3
    s_add_u32 s87, s87, s88
    s_add_u32 s87, s87, 40
    s_lshl_b32 s88, s70, 1
    s_add_u32 s88, s88, s87
    s_lshl_b32 s88, s88, 10
    s_add_u32 s87, s87, 1
    s_mul_i32 s93, s70, 176
    s_add_u32 s87, s87, s93
    s_lshl_b32 s87, s87, 10
    v_add_u32 v81, s88, v51
    v_add_u32 v82, s87, v51
    v_pk_mul_f32 v[120:121], v[120:121], v[136:137]
    v_pk_mul_f32 v[122:123], v[122:123], v[138:139]
    v_pk_mul_f32 v[152:153], v[152:153], v[168:169]
    v_pk_mul_f32 v[154:155], v[154:155], v[170:171]
    v_cvt_pk_bf16_f32 v136, v120, v121
    v_cvt_pk_bf16_f32 v137, v122, v123
    v_cvt_pk_bf16_f32 v138, v152, v153
    v_cvt_pk_bf16_f32 v139, v154, v155
    v_add_u32 v120, 0, v81
    global_store_dwordx4 v120, v[136:139], s[36:37] sc1
    v_pk_mul_f32 v[124:125], v[124:125], v[140:141]
    v_pk_mul_f32 v[126:127], v[126:127], v[142:143]
    v_pk_mul_f32 v[156:157], v[156:157], v[172:173]
    v_pk_mul_f32 v[158:159], v[158:159], v[174:175]
    v_cvt_pk_bf16_f32 v140, v124, v125
    v_cvt_pk_bf16_f32 v141, v126, v127
    v_cvt_pk_bf16_f32 v142, v156, v157
    v_cvt_pk_bf16_f32 v143, v158, v159
    v_add_u32 v124, 90112, v81
    global_store_dwordx4 v124, v[140:143], s[36:37] sc1
    v_pk_mul_f32 v[128:129], v[128:129], v[144:145]
    v_pk_mul_f32 v[130:131], v[130:131], v[146:147]
    v_pk_mul_f32 v[160:161], v[160:161], v[176:177]
    v_pk_mul_f32 v[162:163], v[162:163], v[178:179]
    v_cvt_pk_bf16_f32 v144, v128, v129
    v_cvt_pk_bf16_f32 v145, v130, v131
    v_cvt_pk_bf16_f32 v146, v160, v161
    v_cvt_pk_bf16_f32 v147, v162, v163
    v_add_u32 v128, 180224, v81
    global_store_dwordx4 v128, v[144:147], s[36:37] sc1
    v_pk_mul_f32 v[132:133], v[132:133], v[148:149]
    v_pk_mul_f32 v[134:135], v[134:135], v[150:151]
    v_pk_mul_f32 v[164:165], v[164:165], v[180:181]
    v_pk_mul_f32 v[166:167], v[166:167], v[182:183]
    v_cvt_pk_bf16_f32 v148, v132, v133
    v_cvt_pk_bf16_f32 v149, v134, v135
    v_cvt_pk_bf16_f32 v150, v164, v165
    v_cvt_pk_bf16_f32 v151, v166, v167
    v_add_u32 v132, 270336, v81
    global_store_dwordx4 v132, v[148:151], s[36:37] sc1
    v_pk_mul_f32 v[184:185], v[184:185], v[200:201]
    v_pk_mul_f32 v[186:187], v[186:187], v[202:203]
    v_pk_mul_f32 v[188:189], v[188:189], v[204:205]
    v_pk_mul_f32 v[190:191], v[190:191], v[206:207]
    v_pk_mul_f32 v[192:193], v[192:193], v[208:209]
    v_pk_mul_f32 v[194:195], v[194:195], v[210:211]
    v_pk_mul_f32 v[196:197], v[196:197], v[212:213]
    v_pk_mul_f32 v[198:199], v[198:199], v[214:215]
    v_cvt_pk_bf16_f32 v200, v184, v185
    v_cvt_pk_bf16_f32 v201, v186, v187
    v_cvt_pk_bf16_f32 v204, v188, v189
    v_cvt_pk_bf16_f32 v205, v190, v191
    v_cvt_pk_bf16_f32 v208, v192, v193
    v_cvt_pk_bf16_f32 v209, v194, v195
    v_cvt_pk_bf16_f32 v212, v196, v197
    v_cvt_pk_bf16_f32 v213, v198, v199
    s_lshl_b32 s88, s68, 10
    v_lshlrev_b32 v20, 3, v1
    v_add_u32 v21, s88, v20
    ds_write_b64 v21, v[208:209] offset:51200
    ds_write_b64 v21, v[212:213] offset:51712
    v_mfma_f32_16x16x32_bf16 v[216:219], a[0:3], a[40:43], v[216:219]
    v_add_f32_dpp v73, v73, v73 row_shr:8 row_mask:0xf bank_mask:0xf bound_ctrl:0
    v_add_f32_dpp v74, v74, v74 row_shr:8 row_mask:0xf bank_mask:0xf bound_ctrl:0
    v_mfma_f32_16x16x32_bf16 v[220:223], a[4:7], a[40:43], v[220:223]
    v_add_f32_dpp v73, v73, v73 row_bcast:15 row_mask:0xa bank_mask:0xf
    v_add_f32_dpp v74, v74, v74 row_bcast:15 row_mask:0xa bank_mask:0xf
    v_mfma_f32_16x16x32_bf16 v[224:227], a[8:11], a[40:43], v[224:227]
    v_add_f32_dpp v73, v73, v73 row_bcast:31 row_mask:0xc bank_mask:0xf
    v_add_f32_dpp v74, v74, v74 row_bcast:31 row_mask:0xc bank_mask:0xf
    v_mfma_f32_16x16x32_bf16 v[228:231], a[12:15], a[40:43], v[228:231]
    v_readlane_b32 s82, v73, 63
    v_readlane_b32 s83, v74, 63
    v_mfma_f32_16x16x32_bf16 v[232:235], a[0:3], a[44:47], v[232:235]
    v_cmp_eq_u32 vcc, 0, v1
    v_mfma_f32_16x16x32_bf16 v[236:239], a[4:7], a[44:47], v[236:239]
    v_mov_b32 v78, s82
    v_mov_b32 v77, s83
    v_mfma_f32_16x16x32_bf16 v[240:243], a[8:11], a[44:47], v[240:243]
    v_cndmask_b32 v77, v77, v78, vcc
    v_mfma_f32_16x16x32_bf16 v[244:247], a[12:15], a[44:47], v[244:247]
    v_cvt_pk_bf16_f32 v77, v77, v77
    v_mfma_f32_16x16x32_bf16 v[248:251], a[0:3], a[48:51], v[248:251]
    v_lshlrev_b32 v77, 16, v77
    v_mul_f32 v77, 0xbfb8aa3b, v77
    v_mfma_f32_16x16x32_bf16 v[252:255], a[4:7], a[48:51], v[252:255]
    v_exp_f32 v77, v77
    v_mfma_f32_16x16x32_bf16 v[216:219], a[52:55], a[92:95], v[216:219]
    v_add_f32 v77, 1.0, v77
    v_mfma_f32_16x16x32_bf16 v[220:223], a[56:59], a[92:95], v[220:223]
    v_rcp_f32 v77, v77
    v_mfma_f32_16x16x32_bf16 v[224:227], a[60:63], a[92:95], v[224:227]
    v_cvt_pk_bf16_f32 v77, v77, v77
    v_mfma_f32_16x16x32_bf16 v[228:231], a[64:67], a[92:95], v[228:231]
    v_lshlrev_b32 v72, 16, v77
    s_lshl_b32 s82, s94, 2
    v_mfma_f32_16x16x32_bf16 v[232:235], a[52:55], a[96:99], v[232:235]
    s_add_u32 s82, s82, 11534336
    v_mfma_f32_16x16x32_bf16 v[236:239], a[56:59], a[96:99], v[236:239]
    v_lshl_add_u32 v71, v1, 2, s82
    v_mfma_f32_16x16x32_bf16 v[240:243], a[60:63], a[96:99], v[240:243]
    v_mfma_f32_16x16x32_bf16 v[244:247], a[64:67], a[96:99], v[244:247]
    v_mfma_f32_16x16x32_bf16 v[248:251], a[52:55], a[100:103], v[248:251]
    v_mfma_f32_16x16x32_bf16 v[252:255], a[56:59], a[100:103], v[252:255]
    s_mov_b64 exec, 3
    global_store_dword v71, v72, s[36:37] sc1
    s_mov_b64 exec, -1
    s_branch L_epi
L_blk0:
    s_cmp_eq_u32 s77, 1
    s_cbranch_scc1 L_b0_0
    v_lshlrev_b32 v19, 4, v1
    v_add_u32 v19, 11812864, v19
    global_load_dwordx4 v[52:55], v19, s[36:37] sc1
    s_lshl_b32 s88, s71, 7
    s_lshl_b32 s89, s69, 6
    s_add_u32 s88, s88, s89
    s_lshl_b32 s89, s72, 2
    s_add_u32 s88, s88, s89
    s_lshl_b32 s89, s70, 1
    s_add_u32 s94, s88, s89
    s_mul_i32 s88, s94, 1280
    v_lshlrev_b32 v19, 2, v1
    v_add_u32 v20, s88, v51
    v_add_u32 v21, s88, v19
    global_load_dwordx4 v[56:59], v51, s[30:31]
    global_load_dword v60, v19, s[30:31] offset:1024
    global_load_dwordx4 v[62:65], v20, s[4:5]
    global_load_dword v61, v21, s[4:5] offset:1024
    global_load_dwordx4 v[66:69], v20, s[4:5] offset:1280
    global_load_dword v70, v21, s[4:5] offset:2304
    s_branch L_blkr0
L_b0_0:
    s_mov_b32 s95, 0
L_np0:
    v_readfirstlane_b32 s3, v49
    s_cmp_lg_u32 s3, 0
    s_cbranch_scc1 L_nok0
    s_add_u32 s95, s95, 1
    s_cmp_gt_u32 s95, 100000
    s_cbranch_scc1 L_nok0
    v_mov_b32 v19, 0
    global_load_dword v49, v19, s[34:35] sc1
    s_waitcnt vmcnt(0)
    s_branch L_np0
L_nok0:
    s_cmp_lg_u32 s68, 0
    s_cbranch_scc1 L_blkr0
    s_lshl_b32 s88, s2, 2
    s_add_u32 s88, s88, 11812864
    v_mov_b32 v19, s88
    v_mov_b32 v20, s3
    s_mov_b64 exec, 1
    global_store_dword v19, v20, s[36:37] sc1
    s_mov_b64 exec, -1
    s_branch L_blkr0
L_pre1:
    ds_read_b128 a[0:3], v12 offset:0
    ds_read_b64_tr_b16 a[16:17], v14 offset:16384
    ds_read_b64_tr_b16 a[18:19], v14 offset:17152
    ds_read_b128 a[4:7], v12 offset:512
    ds_read_b128 a[8:11], v12 offset:1024
    ds_read_b128 a[12:15], v12 offset:1536
    ds_read_b64_tr_b16 a[20:21], v14 offset:28672
    ds_read_b64_tr_b16 a[22:23], v14 offset:29440
    ds_read_b64_tr_b16 a[24:25], v15 offset:16384
    ds_read_b64_tr_b16 a[26:27], v15 offset:17152
    ds_read_b64_tr_b16 a[28:29], v15 offset:28672
    ds_read_b64_tr_b16 a[30:31], v15 offset:29440
    ds_read_b64_tr_b16 a[32:33], v16 offset:16384
    ds_read_b64_tr_b16 a[34:35], v16 offset:17152
    ds_read_b64_tr_b16 a[36:37], v16 offset:28672
    ds_read_b64_tr_b16 a[38:39], v16 offset:29440
    ds_read_b128 a[40:43], v17 offset:40960
    ds_read_b128 a[44:47], v17 offset:41984
    ds_read_b128 a[48:51], v17 offset:43008
    v_add_u32 v12, 51200, v12
    v_add_u32 v17, 51200, v17
    ds_read_u16 v52, v69 offset:0
    s_add_u32 m0, s73, s82
    s_nop 0
    buffer_load_dwordx4 v2, s[40:43], s78 offen lds
    ds_read_u16 v53, v69 offset:16
    ds_read_u16 v54, v70 offset:0
    ds_read_u16 v55, v69 offset:256
    ds_read_u16 v56, v69 offset:272
    ds_read_u16 v57, v70 offset:256
    ds_read_u16 v58, v69 offset:512
    ds_read_u16 v59, v69 offset:528
    ds_read_u16 v60, v70 offset:512
    buffer_load_dwordx4 v3, s[40:43], s78 offen offset:1024 lds
    v_cvt_f32_u32 v71, v50
    v_mov_b32 v72, 0x42e00000
    s_mov_b32 s87, 0xc1800000
    v_fma_f32 v71, v71, s87, v72
    s_lshl_b32 s87, s70, 3
    s_sub_u32 s87, 8, s87
    v_cvt_f32_u32 v73, s87
    v_add_f32 v73, v73, v71
    s_waitcnt lgkmcnt(0)
    buffer_load_dwordx4 v4, s[40:43], s78 offen offset:2048 lds
    v_lshlrev_b32 v30, 16, v52
    v_lshlrev_b32 v31, 16, v53
    v_lshlrev_b32 v32, 16, v54
    v_lshlrev_b32 v33, 16, v55
    v_lshlrev_b32 v34, 16, v56
    v_lshlrev_b32 v35, 16, v57
    v_lshlrev_b32 v86, 16, v58
    v_lshlrev_b32 v87, 16, v59
    v_lshlrev_b32 v88, 16, v60
    v_mul_f32 v86, 0x3fb8aa3b, v86
    v_mul_f32 v87, 0x3fb8aa3b, v87
    v_mul_f32 v88, 0x3fb8aa3b, v88
    v_exp_f32 v86, v86
    v_exp_f32 v87, v87
    v_exp_f32 v88, v88
    v_cvt_pk_bf16_f32 v86, v86, v86
    v_cvt_pk_bf16_f32 v87, v87, v87
    v_cvt_pk_bf16_f32 v88, v88, v88
    v_lshlrev_b32 v86, 16, v86
    v_lshlrev_b32 v87, 16, v87
    v_lshlrev_b32 v88, 16, v88
    v_mul_f32 v24, v86, v30
    v_mul_f32 v25, v87, v31
    v_mul_f32 v26, v88, v32
    buffer_load_dwordx4 v5, s[40:43], s78 offen offset:3072 lds
    v_mul_f32 v27, v86, v33
    v_mul_f32 v28, v87, v34
    v_mul_f32 v29, v88, v35
    v_mul_f32 v24, 0x3fb8aa3b, v24
    v_mul_f32 v25, 0x3fb8aa3b, v25
    v_mul_f32 v26, 0x3fb8aa3b, v26
    v_mul_f32 v27, 0x3e22f983, v27
    v_mul_f32 v28, 0x3e22f983, v28
    v_mul_f32 v29, 0x3e22f983, v29
    v_exp_f32 v80, v24
    v_exp_f32 v82, v25
    v_exp_f32 v84, v26
    v_rndne_f32 v36, v27
    v_rndne_f32 v37, v28
    v_rndne_f32 v38, v29
    v_sub_f32 v81, v27, v36
    v_sub_f32 v83, v28, v37
    v_sub_f32 v85, v29, v38
    v_cos_f32 v36, v81
    v_cos_f32 v37, v83
    v_cos_f32 v38, v85
    v_sin_f32 v39, v81
    v_sin_f32 v40, v83
    v_sin_f32 v41, v85
    v_mul_f32 v36, v80, v36
    v_mul_f32 v37, v82, v37
    v_mul_f32 v38, v84, v38
    s_add_u32 m0, s73, s83
    s_nop 0
    buffer_load_dwordx4 v6, s[44:47], s79 offen lds
    v_mul_f32 v80, v48, v80
    v_mul_f32 v82, v48, v82
    v_mul_f32 v84, v48, v84
    v_mul_f32 v39, v80, v39
    v_mul_f32 v40, v82, v40
    v_mul_f32 v41, v84, v41
    v_mul_f32 v80, v71, v24
    v_mul_f32 v82, v71, v25
    v_mul_f32 v84, v73, v26
    v_mul_f32 v81, v71, v27
    v_mul_f32 v83, v71, v28
    v_mul_f32 v85, v73, v29
    v_exp_f32 v80, v80
    v_exp_f32 v82, v82
    v_exp_f32 v84, v84
    v_rndne_f32 v42, v81
    v_rndne_f32 v43, v83
    v_rndne_f32 v44, v85
    v_sub_f32 v81, v81, v42
    v_sub_f32 v83, v83, v43
    v_sub_f32 v85, v85, v44
    v_cos_f32 v42, v81
    v_cos_f32 v43, v83
    v_cos_f32 v44, v85
    buffer_load_dwordx4 v7, s[44:47], s79 offen offset:1024 lds
    v_sin_f32 v45, v81
    v_sin_f32 v46, v83
    v_sin_f32 v47, v85
    v_mul_f32 v42, v80, v42
    v_mul_f32 v43, v82, v43
    v_mul_f32 v44, v84, v44
    v_mul_f32 v80, v48, v80
    v_mul_f32 v82, v48, v82
    v_mul_f32 v84, v48, v84
    v_mul_f32 v45, v80, v45
    v_mul_f32 v46, v82, v46
    v_mul_f32 v47, v84, v47
    s_and_b32 s14, s91, 7
    s_mul_i32 s14, s14, 3200
    v_lshlrev_b32 v83, 7, v1
    v_add_u32 v83, s14, v83
    v_cmp_gt_u32 vcc, 25, v1
    v_mov_b32 v19, 0x7f000000
    s_nop 0
    v_cndmask_b32 v83, v19, v83, vcc
    buffer_load_dwordx4 v8, s[44:47], s79 offen offset:2048 lds
    s_mul_i32 s15, s92, 88
    s_mul_i32 s14, s68, 12
    s_add_u32 s14, s14, s15
    s_add_u32 s14, s14, 47
    s_mul_i32 s14, s14, 5120
    s_mul_i32 s16, s68, 5
    s_add_u32 s15, s15, s16
    s_mul_i32 s15, s15, 5120
    s_add_u32 s16, s15, 102400
    s_waitcnt vmcnt(7)
    ds_read_b64_tr_b16 v[108:109], v68 offset:0
    ds_read_b64_tr_b16 v[110:111], v68 offset:1024
    ds_read_b64_tr_b16 v[112:113], v68 offset:32
    ds_read_b64_tr_b16 v[114:115], v68 offset:1056
    s_mov_b32 s64, s36
    s_mov_b32 s65, s37
    s_mov_b32 s66, 16187392
    s_mov_b32 s67, 0x00020000
    s_cmp_lt_u32 s2, 200
    s_cselect_b32 s66, s66, 0
    buffer_store_dwordx4 v[100:103], v66, s[64:67], 0 offen sc1
    buffer_store_dwordx4 v[104:107], v67, s[64:67], 0 offen sc1
    v_lshlrev_b32 v19, 5, v0
    v_add_u32 v19, 153600, v19
    s_waitcnt lgkmcnt(0)
    s_mov_b32 s66, 16187392
    s_cmp_lt_u32 s2, 240
    s_cselect_b32 s66, s66, 0
    buffer_store_dwordx4 v[108:111], v64, s[64:67], 0 offen sc1
    buffer_store_dwordx4 v[112:115], v65, s[64:67], 0 offen sc1
    ds_write_b128 v19, v[76:79]
    ds_write_b128 v19, v[76:79] offset:16
    v_mov_b32 v20, 0
    global_load_dword v49, v20, s[34:35] sc1
    s_waitcnt lgkmcnt(0)
    .p2align 3
L_loop1:
    v_mfma_f32_16x16x32_bf16 v[120:123], a[16:19], a[0:3], v[120:123]
    ds_read_b128 a[52:55], v13 offset:0
    s_add_u32 m0, s73, s84
    v_mfma_f32_16x16x32_bf16 v[124:127], a[16:19], a[4:7], v[124:127]
    ds_read_b64_tr_b16 a[68:69], v14 offset:22528
    buffer_load_dwordx4 v6, s[48:51], s80 offen lds
    v_mfma_f32_16x16x32_bf16 v[128:131], a[16:19], a[8:11], v[128:131]
    ds_read_b64_tr_b16 a[70:71], v14 offset:23296
    s_add_u32 s78, s78, 128
    v_mfma_f32_16x16x32_bf16 v[132:135], a[16:19], a[12:15], v[132:135]
    ds_read_b128 a[56:59], v13 offset:512
    v_mfma_f32_16x16x32_bf16 v[136:139], a[20:23], a[0:3], v[136:139]
    ds_read_b128 a[60:63], v13 offset:1024
    v_mfma_f32_16x16x32_bf16 v[140:143], a[20:23], a[4:7], v[140:143]
    ds_read_b128 a[64:67], v13 offset:1536
    v_mfma_f32_16x16x32_bf16 v[144:147], a[20:23], a[8:11], v[144:147]
    ds_read_b64_tr_b16 a[72:73], v14 offset:34816
    buffer_load_dwordx4 v7, s[48:51], s80 offen offset:1024 lds
    v_mfma_f32_16x16x32_bf16 v[148:151], a[20:23], a[12:15], v[148:151]
    ds_read_b64_tr_b16 a[74:75], v14 offset:35584
    v_mfma_f32_16x16x32_bf16 v[152:155], a[24:27], a[0:3], v[152:155]
    ds_read_b64_tr_b16 a[76:77], v15 offset:22528
    v_mfma_f32_16x16x32_bf16 v[156:159], a[24:27], a[4:7], v[156:159]
    ds_read_b64_tr_b16 a[78:79], v15 offset:23296
    v_mfma_f32_16x16x32_bf16 v[160:163], a[24:27], a[8:11], v[160:163]
    ds_read_b64_tr_b16 a[80:81], v15 offset:34816
    v_mfma_f32_16x16x32_bf16 v[164:167], a[24:27], a[12:15], v[164:167]
    ds_read_b64_tr_b16 a[82:83], v15 offset:35584
    buffer_load_dwordx4 v8, s[48:51], s80 offen offset:2048 lds
    v_mfma_f32_16x16x32_bf16 v[168:171], a[28:31], a[0:3], v[168:171]
    ds_read_b64_tr_b16 a[84:85], v16 offset:22528
    v_mfma_f32_16x16x32_bf16 v[172:175], a[28:31], a[4:7], v[172:175]
    ds_read_b64_tr_b16 a[86:87], v16 offset:23296
    v_mfma_f32_16x16x32_bf16 v[176:179], a[28:31], a[8:11], v[176:179]
    ds_read_b64_tr_b16 a[88:89], v16 offset:34816
    v_mfma_f32_16x16x32_bf16 v[180:183], a[28:31], a[12:15], v[180:183]
    ds_read_b64_tr_b16 a[90:91], v16 offset:35584
    s_add_u32 m0, s73, s85
    v_mfma_f32_16x16x32_bf16 v[184:187], a[32:35], a[0:3], v[184:187]
    ds_read_b128 a[92:95], v18 offset:40960
    buffer_load_dwordx4 v9, s[52:55], s81 offen lds
    v_mfma_f32_16x16x32_bf16 v[188:191], a[32:35], a[4:7], v[188:191]
    ds_read_b128 a[96:99], v18 offset:41984
    v_mfma_f32_16x16x32_bf16 v[192:195], a[32:35], a[8:11], v[192:195]
    ds_read_b128 a[100:103], v18 offset:43008
    v_mfma_f32_16x16x32_bf16 v[196:199], a[32:35], a[12:15], v[196:199]
    s_cmp_eq_u32 s78, 1280
    s_cselect_b32 s78, 0, s78
    v_mfma_f32_16x16x32_bf16 v[200:203], a[36:39], a[0:3], v[200:203]
    s_mul_i32 s79, s78, 1536
    v_add_u32 v14, s75, v14
    v_mfma_f32_16x16x32_bf16 v[204:207], a[36:39], a[4:7], v[204:207]
    buffer_load_dwordx4 v10, s[56:59], s81 offen offset:1024 lds
    v_add_u32 v15, s75, v15
    v_mfma_f32_16x16x32_bf16 v[208:211], a[36:39], a[8:11], v[208:211]
    v_add_u32 v16, s75, v16
    v_add_u32 v13, s75, v13
    v_mfma_f32_16x16x32_bf16 v[212:215], a[36:39], a[12:15], v[212:215]
    v_add_u32 v18, s75, v18
    v_mfma_f32_16x16x32_bf16 v[216:219], a[0:3], a[40:43], v[216:219]
    s_mov_b32 s87, s74
    s_add_u32 s74, s74, s75
    v_mfma_f32_16x16x32_bf16 v[220:223], a[4:7], a[40:43], v[220:223]
    s_add_u32 m0, s73, s86
    s_add_u32 s76, s76, 1
    v_mfma_f32_16x16x32_bf16 v[224:227], a[8:11], a[40:43], v[224:227]
    buffer_load_dwordx4 v11, s[60:63], s81 offen lds
    v_mfma_f32_16x16x32_bf16 v[228:231], a[12:15], a[40:43], v[228:231]
    s_cmp_eq_u32 s76, 3
    s_cselect_b32 s76, 0, s76
    v_mfma_f32_16x16x32_bf16 v[232:235], a[0:3], a[44:47], v[232:235]
    s_cmp_eq_u32 s76, 2
    s_cselect_b32 s75, 153600, 0
    v_mfma_f32_16x16x32_bf16 v[236:239], a[4:7], a[44:47], v[236:239]
    s_sub_u32 s75, 51200, s75
    v_mfma_f32_16x16x32_bf16 v[240:243], a[8:11], a[44:47], v[240:243]
    v_mfma_f32_16x16x32_bf16 v[244:247], a[12:15], a[44:47], v[244:247]
    v_mfma_f32_16x16x32_bf16 v[248:251], a[8:11], a[48:51], v[248:251]
    v_mfma_f32_16x16x32_bf16 v[252:255], a[12:15], a[48:51], v[252:255]
    s_waitcnt vmcnt(13) lgkmcnt(0)
    s_barrier
    v_mfma_f32_16x16x32_bf16 v[120:123], a[68:71], a[52:55], v[120:123]
    ds_read_b128 a[0:3], v12 offset:0
    s_add_u32 m0, s87, s82
    v_mfma_f32_16x16x32_bf16 v[124:127], a[68:71], a[56:59], v[124:127]
    ds_read_b64_tr_b16 a[16:17], v14 offset:16384
    buffer_load_dwordx4 v2, s[40:43], s78 offen lds
    v_mfma_f32_16x16x32_bf16 v[128:131], a[68:71], a[60:63], v[128:131]
    ds_read_b64_tr_b16 a[18:19], v14 offset:17152
    s_add_u32 s81, s81, 128
    v_mfma_f32_16x16x32_bf16 v[132:135], a[68:71], a[64:67], v[132:135]
    ds_read_b128 a[4:7], v12 offset:512
    v_mfma_f32_16x16x32_bf16 v[136:139], a[72:75], a[52:55], v[136:139]
    ds_read_b128 a[8:11], v12 offset:1024
    v_mfma_f32_16x16x32_bf16 v[140:143], a[72:75], a[56:59], v[140:143]
    ds_read_b128 a[12:15], v12 offset:1536
    buffer_load_dwordx4 v3, s[40:43], s78 offen offset:1024 lds
    v_mfma_f32_16x16x32_bf16 v[144:147], a[72:75], a[60:63], v[144:147]
    ds_read_b64_tr_b16 a[20:21], v14 offset:28672
    v_mfma_f32_16x16x32_bf16 v[148:151], a[72:75], a[64:67], v[148:151]
    ds_read_b64_tr_b16 a[22:23], v14 offset:29440
    v_mfma_f32_16x16x32_bf16 v[152:155], a[76:79], a[52:55], v[152:155]
    ds_read_b64_tr_b16 a[24:25], v15 offset:16384
    v_mfma_f32_16x16x32_bf16 v[156:159], a[76:79], a[56:59], v[156:159]
    ds_read_b64_tr_b16 a[26:27], v15 offset:17152
    buffer_load_dwordx4 v4, s[40:43], s78 offen offset:2048 lds
    v_mfma_f32_16x16x32_bf16 v[160:163], a[76:79], a[60:63], v[160:163]
    ds_read_b64_tr_b16 a[28:29], v15 offset:28672
    v_mfma_f32_16x16x32_bf16 v[164:167], a[76:79], a[64:67], v[164:167]
    ds_read_b64_tr_b16 a[30:31], v15 offset:29440
    v_mfma_f32_16x16x32_bf16 v[168:171], a[80:83], a[52:55], v[168:171]
    ds_read_b64_tr_b16 a[32:33], v16 offset:16384
    v_mfma_f32_16x16x32_bf16 v[172:175], a[80:83], a[56:59], v[172:175]
    ds_read_b64_tr_b16 a[34:35], v16 offset:17152
    buffer_load_dwordx4 v5, s[40:43], s78 offen offset:3072 lds
    v_mfma_f32_16x16x32_bf16 v[176:179], a[80:83], a[60:63], v[176:179]
    ds_read_b64_tr_b16 a[36:37], v16 offset:28672
    v_mfma_f32_16x16x32_bf16 v[180:183], a[80:83], a[64:67], v[180:183]
    ds_read_b64_tr_b16 a[38:39], v16 offset:29440
    v_mfma_f32_16x16x32_bf16 v[184:187], a[84:87], a[52:55], v[184:187]
    ds_read_b128 a[40:43], v17 offset:40960
    v_mfma_f32_16x16x32_bf16 v[188:191], a[84:87], a[56:59], v[188:191]
    ds_read_b128 a[44:47], v17 offset:41984
    s_add_u32 m0, s87, s83
    v_mfma_f32_16x16x32_bf16 v[192:195], a[84:87], a[60:63], v[192:195]
    ds_read_b128 a[48:51], v17 offset:43008
    buffer_load_dwordx4 v6, s[44:47], s79 offen lds
    v_mfma_f32_16x16x32_bf16 v[196:199], a[84:87], a[64:67], v[196:199]
    s_cmp_eq_u32 s81, 1280
    s_cselect_b32 s81, 0, s81
    v_mfma_f32_16x16x32_bf16 v[200:203], a[88:91], a[52:55], v[200:203]
    s_mul_i32 s80, s81, 1536
    v_add_u32 v12, s75, v12
    v_mfma_f32_16x16x32_bf16 v[204:207], a[88:91], a[56:59], v[204:207]
    v_add_u32 v17, s75, v17
    s_mov_b32 s73, s87
    v_mfma_f32_16x16x32_bf16 v[208:211], a[88:91], a[60:63], v[208:211]
    buffer_load_dwordx4 v7, s[44:47], s79 offen offset:1024 lds
    v_mfma_f32_16x16x32_bf16 v[212:215], a[88:91], a[64:67], v[212:215]
    v_mfma_f32_16x16x32_bf16 v[216:219], a[52:55], a[92:95], v[216:219]
    v_mfma_f32_16x16x32_bf16 v[220:223], a[56:59], a[92:95], v[220:223]
    v_mfma_f32_16x16x32_bf16 v[224:227], a[60:63], a[92:95], v[224:227]
    buffer_load_dwordx4 v8, s[44:47], s79 offen offset:2048 lds
    v_mfma_f32_16x16x32_bf16 v[228:231], a[64:67], a[92:95], v[228:231]
    v_mfma_f32_16x16x32_bf16 v[232:235], a[52:55], a[96:99], v[232:235]
    v_mfma_f32_16x16x32_bf16 v[236:239], a[56:59], a[96:99], v[236:239]
    v_mfma_f32_16x16x32_bf16 v[240:243], a[60:63], a[96:99], v[240:243]
    v_mfma_f32_16x16x32_bf16 v[244:247], a[64:67], a[96:99], v[244:247]
    v_mfma_f32_16x16x32_bf16 v[248:251], a[60:63], a[100:103], v[248:251]
    s_bitcmp1_b32 s90, s77
    s_cbranch_scc1 L_blk1
L_blkr1:
    v_mfma_f32_16x16x32_bf16 v[252:255], a[64:67], a[100:103], v[252:255]
    s_add_u32 s77, s77, 1
    s_cmp_lt_u32 s77, 7
    s_waitcnt lgkmcnt(0)
    s_cbranch_scc1 L_loop1
    v_mfma_f32_16x16x32_bf16 v[120:123], a[16:19], a[0:3], v[120:123]
    ds_read_b128 a[52:55], v13 offset:0
    s_add_u32 m0, s73, s84
    v_mfma_f32_16x16x32_bf16 v[124:127], a[16:19], a[4:7], v[124:127]
    ds_read_b64_tr_b16 a[68:69], v14 offset:22528
    buffer_load_dwordx4 v6, s[48:51], s80 offen lds
    v_mfma_f32_16x16x32_bf16 v[128:131], a[16:19], a[8:11], v[128:131]
    ds_read_b64_tr_b16 a[70:71], v14 offset:23296
    v_mfma_f32_16x16x32_bf16 v[132:135], a[16:19], a[12:15], v[132:135]
    ds_read_b128 a[56:59], v13 offset:512
    v_mfma_f32_16x16x32_bf16 v[136:139], a[20:23], a[0:3], v[136:139]
    ds_read_b128 a[60:63], v13 offset:1024
    v_mfma_f32_16x16x32_bf16 v[140:143], a[20:23], a[4:7], v[140:143]
    ds_read_b128 a[64:67], v13 offset:1536
    v_mfma_f32_16x16x32_bf16 v[144:147], a[20:23], a[8:11], v[144:147]
    ds_read_b64_tr_b16 a[72:73], v14 offset:34816
    buffer_load_dwordx4 v7, s[48:51], s80 offen offset:1024 lds
    v_mfma_f32_16x16x32_bf16 v[148:151], a[20:23], a[12:15], v[148:151]
    ds_read_b64_tr_b16 a[74:75], v14 offset:35584
    v_mfma_f32_16x16x32_bf16 v[152:155], a[24:27], a[0:3], v[152:155]
    ds_read_b64_tr_b16 a[76:77], v15 offset:22528
    v_mfma_f32_16x16x32_bf16 v[156:159], a[24:27], a[4:7], v[156:159]
    ds_read_b64_tr_b16 a[78:79], v15 offset:23296
    v_mfma_f32_16x16x32_bf16 v[160:163], a[24:27], a[8:11], v[160:163]
    ds_read_b64_tr_b16 a[80:81], v15 offset:34816
    v_mfma_f32_16x16x32_bf16 v[164:167], a[24:27], a[12:15], v[164:167]
    ds_read_b64_tr_b16 a[82:83], v15 offset:35584
    buffer_load_dwordx4 v8, s[48:51], s80 offen offset:2048 lds
    v_mfma_f32_16x16x32_bf16 v[168:171], a[28:31], a[0:3], v[168:171]
    ds_read_b64_tr_b16 a[84:85], v16 offset:22528
    v_mfma_f32_16x16x32_bf16 v[172:175], a[28:31], a[4:7], v[172:175]
    ds_read_b64_tr_b16 a[86:87], v16 offset:23296
    v_mfma_f32_16x16x32_bf16 v[176:179], a[28:31], a[8:11], v[176:179]
    ds_read_b64_tr_b16 a[88:89], v16 offset:34816
    v_mfma_f32_16x16x32_bf16 v[180:183], a[28:31], a[12:15], v[180:183]
    ds_read_b64_tr_b16 a[90:91], v16 offset:35584
    s_add_u32 m0, s73, s85
    v_mfma_f32_16x16x32_bf16 v[184:187], a[32:35], a[0:3], v[184:187]
    ds_read_b128 a[92:95], v18 offset:40960
    buffer_load_dwordx4 v9, s[52:55], s81 offen lds
    v_mfma_f32_16x16x32_bf16 v[188:191], a[32:35], a[4:7], v[188:191]
    ds_read_b128 a[96:99], v18 offset:41984
    v_mfma_f32_16x16x32_bf16 v[192:195], a[32:35], a[8:11], v[192:195]
    ds_read_b128 a[100:103], v18 offset:43008
    v_mfma_f32_16x16x32_bf16 v[196:199], a[32:35], a[12:15], v[196:199]
    v_add_u32 v14, 51200, v14
    v_add_u32 v15, 51200, v15
    v_mfma_f32_16x16x32_bf16 v[200:203], a[36:39], a[0:3], v[200:203]
    v_add_u32 v16, 51200, v16
    v_add_u32 v13, 51200, v13
    v_mfma_f32_16x16x32_bf16 v[204:207], a[36:39], a[4:7], v[204:207]
    buffer_load_dwordx4 v10, s[56:59], s81 offen offset:1024 lds
    v_add_u32 v18, 51200, v18
    v_mfma_f32_16x16x32_bf16 v[208:211], a[36:39], a[8:11], v[208:211]
    v_mfma_f32_16x16x32_bf16 v[212:215], a[36:39], a[12:15], v[212:215]
    v_mfma_f32_16x16x32_bf16 v[216:219], a[0:3], a[40:43], v[216:219]
    v_mfma_f32_16x16x32_bf16 v[220:223], a[4:7], a[40:43], v[220:223]
    s_add_u32 m0, s73, s86
    v_mfma_f32_16x16x32_bf16 v[224:227], a[8:11], a[40:43], v[224:227]
    buffer_load_dwordx4 v11, s[60:63], s81 offen lds
    v_mfma_f32_16x16x32_bf16 v[228:231], a[12:15], a[40:43], v[228:231]
    v_mfma_f32_16x16x32_bf16 v[232:235], a[0:3], a[44:47], v[232:235]
    v_mfma_f32_16x16x32_bf16 v[236:239], a[4:7], a[44:47], v[236:239]
    v_mfma_f32_16x16x32_bf16 v[240:243], a[8:11], a[44:47], v[240:243]
    v_mfma_f32_16x16x32_bf16 v[244:247], a[12:15], a[44:47], v[244:247]
    v_mfma_f32_16x16x32_bf16 v[248:251], a[8:11], a[48:51], v[248:251]
    v_mfma_f32_16x16x32_bf16 v[252:255], a[12:15], a[48:51], v[252:255]
    s_waitcnt vmcnt(13) lgkmcnt(0)
    s_barrier
    s_mov_b32 s95, 0
L_pf1:
    v_cmp_ne_u32 vcc, s3, v52
    v_cmp_ne_u32 s[38:39], s3, v53
    s_or_b64 vcc, vcc, s[38:39]
    v_cmp_ne_u32 s[38:39], s3, v54
    s_or_b64 vcc, vcc, s[38:39]
    v_cmp_ne_u32 s[38:39], s3, v55
    s_or_b64 vcc, vcc, s[38:39]
    s_cmp_eq_u64 vcc, 0
    s_cbranch_scc1 L_pfok1
    s_add_u32 s95, s95, 1
    s_cmp_gt_u32 s95, 100000
    s_cbranch_scc1 L_pfok1
    v_lshlrev_b32 v19, 4, v1
    v_add_u32 v19, 11812864, v19
    global_load_dwordx4 v[52:55], v19, s[36:37] sc1
    s_waitcnt vmcnt(0)
    s_branch L_pf1
L_pfok1:
    s_add_u32 s40, s36, 12582912
    s_addc_u32 s41, s37, 0
    s_mov_b32 s42, 3604480
    s_mov_b32 s43, 0x00020000
    s_mul_i32 s78, s92, 88
    s_mul_i32 s87, s68, 12
    s_add_u32 s78, s78, s87
    s_add_u32 s78, s78, 40
    s_mul_i32 s78, s78, 5120
    s_add_u32 s79, s78, 4096
    v_mfma_f32_16x16x32_bf16 v[120:123], a[68:71], a[52:55], v[120:123]
    ds_read_b128 a[0:3], v12 offset:0
    v_mfma_f32_16x16x32_bf16 v[124:127], a[68:71], a[56:59], v[124:127]
    ds_read_b64_tr_b16 a[16:17], v14 offset:16384
    buffer_load_dwordx4 a[104:107], v51, s[40:43], s78 offen sc1
    v_mfma_f32_16x16x32_bf16 v[128:131], a[68:71], a[60:63], v[128:131]
    ds_read_b64_tr_b16 a[18:19], v14 offset:17152
    v_mfma_f32_16x16x32_bf16 v[132:135], a[68:71], a[64:67], v[132:135]
    ds_read_b128 a[4:7], v12 offset:512
    v_mfma_f32_16x16x32_bf16 v[136:139], a[72:75], a[52:55], v[136:139]
    ds_read_b128 a[8:11], v12 offset:1024
    buffer_load_dwordx4 a[108:111], v51, s[40:43], s78 offen offset:1024 sc1
    v_mfma_f32_16x16x32_bf16 v[140:143], a[72:75], a[56:59], v[140:143]
    ds_read_b128 a[12:15], v12 offset:1536
    v_mfma_f32_16x16x32_bf16 v[144:147], a[72:75], a[60:63], v[144:147]
    ds_read_b64_tr_b16 a[20:21], v14 offset:28672
    v_mfma_f32_16x16x32_bf16 v[148:151], a[72:75], a[64:67], v[148:151]
    ds_read_b64_tr_b16 a[22:23], v14 offset:29440
    v_mfma_f32_16x16x32_bf16 v[152:155], a[76:79], a[52:55], v[152:155]
    ds_read_b64_tr_b16 a[24:25], v15 offset:16384
    buffer_load_dwordx4 a[112:115], v51, s[40:43], s78 offen offset:2048 sc1
    v_mfma_f32_16x16x32_bf16 v[156:159], a[76:79], a[56:59], v[156:159]
    ds_read_b64_tr_b16 a[26:27], v15 offset:17152
    v_mfma_f32_16x16x32_bf16 v[160:163], a[76:79], a[60:63], v[160:163]
    ds_read_b64_tr_b16 a[28:29], v15 offset:28672
    v_mfma_f32_16x16x32_bf16 v[164:167], a[76:79], a[64:67], v[164:167]
    ds_read_b64_tr_b16 a[30:31], v15 offset:29440
    v_mfma_f32_16x16x32_bf16 v[168:171], a[80:83], a[52:55], v[168:171]
    ds_read_b64_tr_b16 a[32:33], v16 offset:16384
    buffer_load_dwordx4 a[116:119], v51, s[40:43], s78 offen offset:3072 sc1
    v_mfma_f32_16x16x32_bf16 v[172:175], a[80:83], a[56:59], v[172:175]
    ds_read_b64_tr_b16 a[34:35], v16 offset:17152
    v_mfma_f32_16x16x32_bf16 v[176:179], a[80:83], a[60:63], v[176:179]
    ds_read_b64_tr_b16 a[36:37], v16 offset:28672
    v_mfma_f32_16x16x32_bf16 v[180:183], a[80:83], a[64:67], v[180:183]
    ds_read_b64_tr_b16 a[38:39], v16 offset:29440
    v_mfma_f32_16x16x32_bf16 v[184:187], a[84:87], a[52:55], v[184:187]
    ds_read_b128 a[40:43], v17 offset:40960
    buffer_load_dwordx4 a[120:123], v51, s[40:43], s79 offen sc1
    v_mfma_f32_16x16x32_bf16 v[188:191], a[84:87], a[56:59], v[188:191]
    ds_read_b128 a[44:47], v17 offset:41984
    s_add_u32 s78, s78, 5120
    v_mfma_f32_16x16x32_bf16 v[192:195], a[84:87], a[60:63], v[192:195]
    ds_read_b128 a[48:51], v17 offset:43008
    s_add_u32 s79, s79, 5120
    v_mfma_f32_16x16x32_bf16 v[196:199], a[84:87], a[64:67], v[196:199]
    buffer_load_dwordx4 a[124:127], v51, s[40:43], s78 offen sc1
    v_add_u32 v12, 0xfffe7000, v12
    v_mfma_f32_16x16x32_bf16 v[200:203], a[88:91], a[52:55], v[200:203]
    v_add_u32 v17, 0xfffe7000, v17
    v_mfma_f32_16x16x32_bf16 v[204:207], a[88:91], a[56:59], v[204:207]
    v_mov_b32 v73, 0
    v_mov_b32 v74, 0
    v_mfma_f32_16x16x32_bf16 v[208:211], a[88:91], a[60:63], v[208:211]
    v_lshlrev_b32 v75, 16, v56
    v_and_b32 v76, 0xffff0000, v56
    v_mfma_f32_16x16x32_bf16 v[212:215], a[88:91], a[64:67], v[212:215]
    buffer_load_dwordx4 a[128:131], v51, s[40:43], s78 offen offset:1024 sc1
    v_mfma_f32_16x16x32_bf16 v[216:219], a[52:55], a[92:95], v[216:219]
    v_lshlrev_b32 v77, 16, v62
    v_and_b32 v78, 0xffff0000, v62
    v_mfma_f32_16x16x32_bf16 v[220:223], a[56:59], a[92:95], v[220:223]
    v_mul_f32 v77, v77, v75
    v_mul_f32 v78, v78, v76
    v_mfma_f32_16x16x32_bf16 v[224:227], a[60:63], a[92:95], v[224:227]
    v_cvt_pk_bf16_f32 v77, v77, v78
    v_and_b32 v78, 0xffff0000, v77
    v_mfma_f32_16x16x32_bf16 v[228:231], a[64:67], a[92:95], v[228:231]
    buffer_load_dwordx4 a[132:135], v51, s[40:43], s78 offen offset:2048 sc1
    v_mfma_f32_16x16x32_bf16 v[232:235], a[52:55], a[96:99], v[232:235]
    v_lshlrev_b32 v77, 16, v77
    v_add_f32 v73, v73, v77
    v_mfma_f32_16x16x32_bf16 v[236:239], a[56:59], a[96:99], v[236:239]
    v_add_f32 v73, v73, v78
    v_lshlrev_b32 v77, 16, v66
    v_mfma_f32_16x16x32_bf16 v[240:243], a[60:63], a[96:99], v[240:243]
    v_and_b32 v78, 0xffff0000, v66
    v_mul_f32 v77, v77, v75
    v_mfma_f32_16x16x32_bf16 v[244:247], a[64:67], a[96:99], v[244:247]
    v_mul_f32 v78, v78, v76
    v_cvt_pk_bf16_f32 v77, v77, v78
    v_mfma_f32_16x16x32_bf16 v[248:251], a[60:63], a[100:103], v[248:251]
    v_and_b32 v78, 0xffff0000, v77
    v_lshlrev_b32 v77, 16, v77
    v_mfma_f32_16x16x32_bf16 v[252:255], a[64:67], a[100:103], v[252:255]
    v_add_f32 v74, v74, v77
    v_add_f32 v74, v74, v78
    s_waitcnt lgkmcnt(0)
    v_mfma_f32_16x16x32_bf16 v[120:123], a[16:19], a[0:3], v[120:123]
    ds_read_b128 a[52:55], v13 offset:0
    v_mfma_f32_16x16x32_bf16 v[124:127], a[16:19], a[4:7], v[124:127]
    ds_read_b64_tr_b16 a[68:69], v14 offset:22528
    buffer_load_dwordx4 a[136:139], v51, s[40:43], s78 offen offset:3072 sc1
    v_mfma_f32_16x16x32_bf16 v[128:131], a[16:19], a[8:11], v[128:131]
    ds_read_b64_tr_b16 a[70:71], v14 offset:23296
    v_mfma_f32_16x16x32_bf16 v[132:135], a[16:19], a[12:15], v[132:135]
    ds_read_b128 a[56:59], v13 offset:512
    v_mfma_f32_16x16x32_bf16 v[136:139], a[20:23], a[0:3], v[136:139]
    ds_read_b128 a[60:63], v13 offset:1024
    buffer_load_dwordx4 a[140:143], v51, s[40:43], s79 offen sc1
    v_mfma_f32_16x16x32_bf16 v[140:143], a[20:23], a[4:7], v[140:143]
    ds_read_b128 a[64:67], v13 offset:1536
    v_mfma_f32_16x16x32_bf16 v[144:147], a[20:23], a[8:11], v[144:147]
    ds_read_b64_tr_b16 a[72:73], v14 offset:34816
    s_add_u32 s78, s78, 5120
    v_mfma_f32_16x16x32_bf16 v[148:151], a[20:23], a[12:15], v[148:151]
    ds_read_b64_tr_b16 a[74:75], v14 offset:35584
    s_add_u32 s79, s79, 5120
    v_mfma_f32_16x16x32_bf16 v[152:155], a[24:27], a[0:3], v[152:155]
    ds_read_b64_tr_b16 a[76:77], v15 offset:22528
    buffer_load_dwordx4 a[144:147], v51, s[40:43], s78 offen sc1
    v_mfma_f32_16x16x32_bf16 v[156:159], a[24:27], a[4:7], v[156:159]
    ds_read_b64_tr_b16 a[78:79], v15 offset:23296
    v_mfma_f32_16x16x32_bf16 v[160:163], a[24:27], a[8:11], v[160:163]
    ds_read_b64_tr_b16 a[80:81], v15 offset:34816
    v_mfma_f32_16x16x32_bf16 v[164:167], a[24:27], a[12:15], v[164:167]
    ds_read_b64_tr_b16 a[82:83], v15 offset:35584
    v_mfma_f32_16x16x32_bf16 v[168:171], a[28:31], a[0:3], v[168:171]
    ds_read_b64_tr_b16 a[84:85], v16 offset:22528
    buffer_load_dwordx4 a[148:151], v51, s[40:43], s78 offen offset:1024 sc1
    v_mfma_f32_16x16x32_bf16 v[172:175], a[28:31], a[4:7], v[172:175]
    ds_read_b64_tr_b16 a[86:87], v16 offset:23296
    v_mfma_f32_16x16x32_bf16 v[176:179], a[28:31], a[8:11], v[176:179]
    ds_read_b64_tr_b16 a[88:89], v16 offset:34816
    v_mfma_f32_16x16x32_bf16 v[180:183], a[28:31], a[12:15], v[180:183]
    ds_read_b64_tr_b16 a[90:91], v16 offset:35584
    v_mfma_f32_16x16x32_bf16 v[184:187], a[32:35], a[0:3], v[184:187]
    ds_read_b128 a[92:95], v18 offset:40960
    buffer_load_dwordx4 a[152:155], v51, s[40:43], s78 offen offset:2048 sc1
    v_mfma_f32_16x16x32_bf16 v[188:191], a[32:35], a[4:7], v[188:191]
    ds_read_b128 a[96:99], v18 offset:41984
    v_mfma_f32_16x16x32_bf16 v[192:195], a[32:35], a[8:11], v[192:195]
    ds_read_b128 a[100:103], v18 offset:43008
    v_mfma_f32_16x16x32_bf16 v[196:199], a[32:35], a[12:15], v[196:199]
    buffer_load_dwordx4 a[156:159], v51, s[40:43], s78 offen offset:3072 sc1
    v_add_u32 v14, 0xfffe7000, v14
    v_mfma_f32_16x16x32_bf16 v[200:203], a[36:39], a[0:3], v[200:203]
    v_add_u32 v15, 0xfffe7000, v15
    v_add_u32 v16, 0xfffe7000, v16
    v_mfma_f32_16x16x32_bf16 v[204:207], a[36:39], a[4:7], v[204:207]
    v_add_u32 v13, 0xfffe7000, v13
    v_add_u32 v18, 0xfffe7000, v18
    v_mfma_f32_16x16x32_bf16 v[208:211], a[36:39], a[8:11], v[208:211]
    v_lshlrev_b32 v75, 16, v57
    v_and_b32 v76, 0xffff0000, v57
    v_mfma_f32_16x16x32_bf16 v[212:215], a[36:39], a[12:15], v[212:215]
    buffer_load_dwordx4 a[160:163], v51, s[40:43], s79 offen sc1
    v_mfma_f32_16x16x32_bf16 v[216:219], a[0:3], a[40:43], v[216:219]
    v_lshlrev_b32 v77, 16, v63
    v_and_b32 v78, 0xffff0000, v63
    v_mfma_f32_16x16x32_bf16 v[220:223], a[4:7], a[40:43], v[220:223]
    v_mul_f32 v77, v77, v75
    v_mul_f32 v78, v78, v76
    v_mfma_f32_16x16x32_bf16 v[224:227], a[8:11], a[40:43], v[224:227]
    s_add_u32 s79, s79, 5120
    s_add_u32 s78, s78, 5120
    v_mfma_f32_16x16x32_bf16 v[228:231], a[12:15], a[40:43], v[228:231]
    buffer_load_dwordx4 a[164:167], v51, s[40:43], s78 offen sc1
    v_mfma_f32_16x16x32_bf16 v[232:235], a[0:3], a[44:47], v[232:235]
    v_cvt_pk_bf16_f32 v77, v77, v78
    v_and_b32 v78, 0xffff0000, v77
    v_mfma_f32_16x16x32_bf16 v[236:239], a[4:7], a[44:47], v[236:239]
    v_lshlrev_b32 v77, 16, v77
    v_add_f32 v73, v73, v77
    v_mfma_f32_16x16x32_bf16 v[240:243], a[8:11], a[44:47], v[240:243]
    v_add_f32 v73, v73, v78
    v_lshlrev_b32 v77, 16, v67
    v_mfma_f32_16x16x32_bf16 v[244:247], a[12:15], a[44:47], v[244:247]
    v_and_b32 v78, 0xffff0000, v67
    v_mul_f32 v77, v77, v75
    v_mfma_f32_16x16x32_bf16 v[248:251], a[8:11], a[48:51], v[248:251]
    v_mul_f32 v78, v78, v76
    v_cvt_pk_bf16_f32 v77, v77, v78
    v_mfma_f32_16x16x32_bf16 v[252:255], a[12:15], a[48:51], v[252:255]
    v_and_b32 v78, 0xffff0000, v77
    v_lshlrev_b32 v77, 16, v77
    s_waitcnt vmcnt(16) lgkmcnt(0)
    s_barrier
    v_mfma_f32_16x16x32_bf16 v[120:123], a[68:71], a[52:55], v[120:123]
    ds_read_b128 a[0:3], v12 offset:0
    v_mfma_f32_16x16x32_bf16 v[124:127], a[68:71], a[56:59], v[124:127]
    ds_read_b64_tr_b16 a[16:17], v14 offset:16384
    buffer_load_dwordx4 a[168:171], v51, s[40:43], s78 offen offset:1024 sc1
    v_mfma_f32_16x16x32_bf16 v[128:131], a[68:71], a[60:63], v[128:131]
    ds_read_b64_tr_b16 a[18:19], v14 offset:17152
    v_mfma_f32_16x16x32_bf16 v[132:135], a[68:71], a[64:67], v[132:135]
    ds_read_b128 a[4:7], v12 offset:512
    v_mfma_f32_16x16x32_bf16 v[136:139], a[72:75], a[52:55], v[136:139]
    ds_read_b128 a[8:11], v12 offset:1024
    buffer_load_dwordx4 a[172:175], v51, s[40:43], s78 offen offset:2048 sc1
    v_mfma_f32_16x16x32_bf16 v[140:143], a[72:75], a[56:59], v[140:143]
    ds_read_b128 a[12:15], v12 offset:1536
    v_mfma_f32_16x16x32_bf16 v[144:147], a[72:75], a[60:63], v[144:147]
    ds_read_b64_tr_b16 a[20:21], v14 offset:28672
    v_mfma_f32_16x16x32_bf16 v[148:151], a[72:75], a[64:67], v[148:151]
    ds_read_b64_tr_b16 a[22:23], v14 offset:29440
    v_mfma_f32_16x16x32_bf16 v[152:155], a[76:79], a[52:55], v[152:155]
    ds_read_b64_tr_b16 a[24:25], v15 offset:16384
    buffer_load_dwordx4 a[176:179], v51, s[40:43], s78 offen offset:3072 sc1
    v_mfma_f32_16x16x32_bf16 v[156:159], a[76:79], a[56:59], v[156:159]
    ds_read_b64_tr_b16 a[26:27], v15 offset:17152
    v_mfma_f32_16x16x32_bf16 v[160:163], a[76:79], a[60:63], v[160:163]
    ds_read_b64_tr_b16 a[28:29], v15 offset:28672
    v_mfma_f32_16x16x32_bf16 v[164:167], a[76:79], a[64:67], v[164:167]
    ds_read_b64_tr_b16 a[30:31], v15 offset:29440
    v_mfma_f32_16x16x32_bf16 v[168:171], a[80:83], a[52:55], v[168:171]
    ds_read_b64_tr_b16 a[32:33], v16 offset:16384
    buffer_load_dwordx4 a[180:183], v51, s[40:43], s79 offen sc1
    v_mfma_f32_16x16x32_bf16 v[172:175], a[80:83], a[56:59], v[172:175]
    ds_read_b64_tr_b16 a[34:35], v16 offset:17152
    v_mfma_f32_16x16x32_bf16 v[176:179], a[80:83], a[60:63], v[176:179]
    ds_read_b64_tr_b16 a[36:37], v16 offset:28672
    s_add_u32 s78, s78, 5120
    v_mfma_f32_16x16x32_bf16 v[180:183], a[80:83], a[64:67], v[180:183]
    ds_read_b64_tr_b16 a[38:39], v16 offset:29440
    s_add_u32 s79, s79, 5120
    v_mfma_f32_16x16x32_bf16 v[184:187], a[84:87], a[52:55], v[184:187]
    ds_read_b128 a[40:43], v17 offset:40960
    buffer_load_dwordx4 a[184:187], v51, s[40:43], s78 offen sc1
    v_mfma_f32_16x16x32_bf16 v[188:191], a[84:87], a[56:59], v[188:191]
    ds_read_b128 a[44:47], v17 offset:41984
    v_mfma_f32_16x16x32_bf16 v[192:195], a[84:87], a[60:63], v[192:195]
    ds_read_b128 a[48:51], v17 offset:43008
    v_mfma_f32_16x16x32_bf16 v[196:199], a[84:87], a[64:67], v[196:199]
    buffer_load_dwordx4 a[188:191], v51, s[40:43], s78 offen offset:1024 sc1
    v_mfma_f32_16x16x32_bf16 v[200:203], a[88:91], a[52:55], v[200:203]
    v_add_f32 v74, v74, v77
    v_add_f32 v74, v74, v78
    v_mfma_f32_16x16x32_bf16 v[204:207], a[88:91], a[56:59], v[204:207]
    v_lshlrev_b32 v75, 16, v58
    v_and_b32 v76, 0xffff0000, v58
    v_mfma_f32_16x16x32_bf16 v[208:211], a[88:91], a[60:63], v[208:211]
    v_lshlrev_b32 v77, 16, v64
    v_and_b32 v78, 0xffff0000, v64
    v_mfma_f32_16x16x32_bf16 v[212:215], a[88:91], a[64:67], v[212:215]
    buffer_load_dwordx4 a[192:195], v51, s[40:43], s78 offen offset:2048 sc1
    v_mfma_f32_16x16x32_bf16 v[216:219], a[52:55], a[92:95], v[216:219]
    v_mul_f32 v77, v77, v75
    v_mul_f32 v78, v78, v76
    v_mfma_f32_16x16x32_bf16 v[220:223], a[56:59], a[92:95], v[220:223]
    v_cvt_pk_bf16_f32 v77, v77, v78
    v_and_b32 v78, 0xffff0000, v77
    v_mfma_f32_16x16x32_bf16 v[224:227], a[60:63], a[92:95], v[224:227]
    v_lshlrev_b32 v77, 16, v77
    v_add_f32 v73, v73, v77
    v_mfma_f32_16x16x32_bf16 v[228:231], a[64:67], a[92:95], v[228:231]
    buffer_load_dwordx4 a[196:199], v51, s[40:43], s78 offen offset:3072 sc1
    v_mfma_f32_16x16x32_bf16 v[232:235], a[52:55], a[96:99], v[232:235]
    v_add_f32 v73, v73, v78
    v_lshlrev_b32 v77, 16, v68
    v_mfma_f32_16x16x32_bf16 v[236:239], a[56:59], a[96:99], v[236:239]
    v_and_b32 v78, 0xffff0000, v68
    v_mul_f32 v77, v77, v75
    v_mfma_f32_16x16x32_bf16 v[240:243], a[60:63], a[96:99], v[240:243]
    v_mul_f32 v78, v78, v76
    v_cvt_pk_bf16_f32 v77, v77, v78
    v_mfma_f32_16x16x32_bf16 v[244:247], a[64:67], a[96:99], v[244:247]
    v_and_b32 v78, 0xffff0000, v77
    v_lshlrev_b32 v77, 16, v77
    v_mfma_f32_16x16x32_bf16 v[248:251], a[60:63], a[100:103], v[248:251]
    v_add_f32 v74, v74, v77
    v_add_f32 v74, v74, v78
    v_mfma_f32_16x16x32_bf16 v[252:255], a[64:67], a[100:103], v[252:255]
    v_lshlrev_b32 v75, 16, v59
    v_and_b32 v76, 0xffff0000, v59
    s_waitcnt lgkmcnt(0)
    v_mfma_f32_16x16x32_bf16 v[120:123], a[16:19], a[0:3], v[120:123]
    ds_read_b128 a[52:55], v13 offset:0
    v_mfma_f32_16x16x32_bf16 v[124:127], a[16:19], a[4:7], v[124:127]
    ds_read_b64_tr_b16 a[68:69], v14 offset:22528
    buffer_load_dwordx4 a[200:203], v51, s[40:43], s79 offen sc1
    v_mfma_f32_16x16x32_bf16 v[128:131], a[16:19], a[8:11], v[128:131]
    ds_read_b64_tr_b16 a[70:71], v14 offset:23296
    s_add_u32 s78, s78, 5120
    v_mfma_f32_16x16x32_bf16 v[132:135], a[16:19], a[12:15], v[132:135]
    ds_read_b128 a[56:59], v13 offset:512
    s_add_u32 s79, s79, 5120
    v_mfma_f32_16x16x32_bf16 v[136:139], a[20:23], a[0:3], v[136:139]
    ds_read_b128 a[60:63], v13 offset:1024
    buffer_load_dwordx4 a[204:207], v51, s[40:43], s78 offen sc1
    v_mfma_f32_16x16x32_bf16 v[140:143], a[20:23], a[4:7], v[140:143]
    ds_read_b128 a[64:67], v13 offset:1536
    v_mfma_f32_16x16x32_bf16 v[144:147], a[20:23], a[8:11], v[144:147]
    ds_read_b64_tr_b16 a[72:73], v14 offset:34816
    v_mfma_f32_16x16x32_bf16 v[148:151], a[20:23], a[12:15], v[148:151]
    ds_read_b64_tr_b16 a[74:75], v14 offset:35584
    buffer_load_dwordx4 a[208:211], v51, s[40:43], s78 offen offset:1024 sc1
    v_mfma_f32_16x16x32_bf16 v[152:155], a[24:27], a[0:3], v[152:155]
    ds_read_b64_tr_b16 a[76:77], v15 offset:22528
    v_mfma_f32_16x16x32_bf16 v[156:159], a[24:27], a[4:7], v[156:159]
    ds_read_b64_tr_b16 a[78:79], v15 offset:23296
    v_mfma_f32_16x16x32_bf16 v[160:163], a[24:27], a[8:11], v[160:163]
    ds_read_b64_tr_b16 a[80:81], v15 offset:34816
    v_mfma_f32_16x16x32_bf16 v[164:167], a[24:27], a[12:15], v[164:167]
    ds_read_b64_tr_b16 a[82:83], v15 offset:35584
    buffer_load_dwordx4 a[212:215], v51, s[40:43], s78 offen offset:2048 sc1
    v_mfma_f32_16x16x32_bf16 v[168:171], a[28:31], a[0:3], v[168:171]
    ds_read_b64_tr_b16 a[84:85], v16 offset:22528
    v_mfma_f32_16x16x32_bf16 v[172:175], a[28:31], a[4:7], v[172:175]
    ds_read_b64_tr_b16 a[86:87], v16 offset:23296
    v_mfma_f32_16x16x32_bf16 v[176:179], a[28:31], a[8:11], v[176:179]
    ds_read_b64_tr_b16 a[88:89], v16 offset:34816
    buffer_load_dwordx4 a[216:219], v51, s[40:43], s78 offen offset:3072 sc1
    v_mfma_f32_16x16x32_bf16 v[180:183], a[28:31], a[12:15], v[180:183]
    ds_read_b64_tr_b16 a[90:91], v16 offset:35584
    v_mfma_f32_16x16x32_bf16 v[184:187], a[32:35], a[0:3], v[184:187]
    ds_read_b128 a[92:95], v18 offset:40960
    v_mfma_f32_16x16x32_bf16 v[188:191], a[32:35], a[4:7], v[188:191]
    ds_read_b128 a[96:99], v18 offset:41984
    buffer_load_dwordx4 a[220:223], v51, s[40:43], s79 offen sc1
    v_mfma_f32_16x16x32_bf16 v[192:195], a[32:35], a[8:11], v[192:195]
    ds_read_b128 a[100:103], v18 offset:43008
    s_add_u32 s78, s78, 5120
    v_mfma_f32_16x16x32_bf16 v[196:199], a[32:35], a[12:15], v[196:199]
    s_add_u32 s79, s79, 5120
    v_mfma_f32_16x16x32_bf16 v[200:203], a[36:39], a[0:3], v[200:203]
    v_lshlrev_b32 v77, 16, v65
    v_and_b32 v78, 0xffff0000, v65
    v_mfma_f32_16x16x32_bf16 v[204:207], a[36:39], a[4:7], v[204:207]
    v_mul_f32 v77, v77, v75
    v_mul_f32 v78, v78, v76
    v_mfma_f32_16x16x32_bf16 v[208:211], a[36:39], a[8:11], v[208:211]
    v_cvt_pk_bf16_f32 v77, v77, v78
    v_and_b32 v78, 0xffff0000, v77
    v_mfma_f32_16x16x32_bf16 v[212:215], a[36:39], a[12:15], v[212:215]
    v_lshlrev_b32 v77, 16, v77
    v_add_f32 v73, v73, v77
    s_waitcnt lgkmcnt(0)
    v_mfma_f32_16x16x32_bf16 v[120:123], a[68:71], a[52:55], v[120:123]
    v_add_f32 v73, v73, v78
    v_lshlrev_b32 v77, 16, v69
    v_mfma_f32_16x16x32_bf16 v[124:127], a[68:71], a[56:59], v[124:127]
    buffer_load_dwordx4 a[224:227], v51, s[40:43], s78 offen sc1
    v_mfma_f32_16x16x32_bf16 v[128:131], a[68:71], a[60:63], v[128:131]
    v_and_b32 v78, 0xffff0000, v69
    v_mul_f32 v77, v77, v75
    v_mfma_f32_16x16x32_bf16 v[132:135], a[68:71], a[64:67], v[132:135]
    v_mul_f32 v78, v78, v76
    v_cvt_pk_bf16_f32 v77, v77, v78
    v_mfma_f32_16x16x32_bf16 v[136:139], a[72:75], a[52:55], v[136:139]
    v_and_b32 v78, 0xffff0000, v77
    v_lshlrev_b32 v77, 16, v77
    v_mfma_f32_16x16x32_bf16 v[140:143], a[72:75], a[56:59], v[140:143]
    buffer_load_dwordx4 a[228:231], v51, s[40:43], s78 offen offset:1024 sc1
    v_mfma_f32_16x16x32_bf16 v[144:147], a[72:75], a[60:63], v[144:147]
    v_add_f32 v74, v74, v77
    v_add_f32 v74, v74, v78
    v_mfma_f32_16x16x32_bf16 v[148:151], a[72:75], a[64:67], v[148:151]
    v_lshlrev_b32 v75, 16, v60
    v_and_b32 v76, 0xffff0000, v60
    v_mfma_f32_16x16x32_bf16 v[152:155], a[76:79], a[52:55], v[152:155]
    v_lshlrev_b32 v77, 16, v61
    v_and_b32 v78, 0xffff0000, v61
    v_mfma_f32_16x16x32_bf16 v[156:159], a[76:79], a[56:59], v[156:159]
    buffer_load_dwordx4 a[232:235], v51, s[40:43], s78 offen offset:2048 sc1
    v_mfma_f32_16x16x32_bf16 v[160:163], a[76:79], a[60:63], v[160:163]
    v_mul_f32 v77, v77, v75
    v_mul_f32 v78, v78, v76
    v_mfma_f32_16x16x32_bf16 v[164:167], a[76:79], a[64:67], v[164:167]
    v_cvt_pk_bf16_f32 v77, v77, v78
    v_and_b32 v78, 0xffff0000, v77
    v_mfma_f32_16x16x32_bf16 v[168:171], a[80:83], a[52:55], v[168:171]
    v_lshlrev_b32 v77, 16, v77
    v_add_f32 v73, v73, v77
    v_mfma_f32_16x16x32_bf16 v[172:175], a[80:83], a[56:59], v[172:175]
    buffer_load_dwordx4 a[236:239], v51, s[40:43], s78 offen offset:3072 sc1
    v_mfma_f32_16x16x32_bf16 v[176:179], a[80:83], a[60:63], v[176:179]
    v_add_f32 v73, v73, v78
    v_lshlrev_b32 v77, 16, v70
    v_mfma_f32_16x16x32_bf16 v[180:183], a[80:83], a[64:67], v[180:183]
    v_and_b32 v78, 0xffff0000, v70
    v_mul_f32 v77, v77, v75
    v_mfma_f32_16x16x32_bf16 v[184:187], a[84:87], a[52:55], v[184:187]
    v_mul_f32 v78, v78, v76
    v_cvt_pk_bf16_f32 v77, v77, v78
    v_mfma_f32_16x16x32_bf16 v[188:191], a[84:87], a[56:59], v[188:191]
    buffer_load_dwordx4 a[240:243], v51, s[40:43], s79 offen sc1
    v_mfma_f32_16x16x32_bf16 v[192:195], a[84:87], a[60:63], v[192:195]
    s_add_u32 s78, s78, 5120
    s_add_u32 s79, s79, 5120
    v_mfma_f32_16x16x32_bf16 v[196:199], a[84:87], a[64:67], v[196:199]
    v_and_b32 v78, 0xffff0000, v77
    v_lshlrev_b32 v77, 16, v77
    v_mfma_f32_16x16x32_bf16 v[200:203], a[88:91], a[52:55], v[200:203]
    v_add_f32 v74, v74, v77
    v_add_f32 v74, v74, v78
    v_mfma_f32_16x16x32_bf16 v[204:207], a[88:91], a[56:59], v[204:207]
    v_add_f32_dpp v73, v73, v73 row_shr:1 row_mask:0xf bank_mask:0xf bound_ctrl:0
    v_add_f32_dpp v74, v74, v74 row_shr:1 row_mask:0xf bank_mask:0xf bound_ctrl:0
    v_mfma_f32_16x16x32_bf16 v[208:211], a[88:91], a[60:63], v[208:211]
    v_add_f32_dpp v73, v73, v73 row_shr:2 row_mask:0xf bank_mask:0xf bound_ctrl:0
    v_add_f32_dpp v74, v74, v74 row_shr:2 row_mask:0xf bank_mask:0xf bound_ctrl:0
    v_mfma_f32_16x16x32_bf16 v[212:215], a[88:91], a[64:67], v[212:215]
    v_add_f32_dpp v73, v73, v73 row_shr:4 row_mask:0xf bank_mask:0xf bound_ctrl:0
    v_add_f32_dpp v74, v74, v74 row_shr:4 row_mask:0xf bank_mask:0xf bound_ctrl:0
    s_lshl_b32 s87, s71, 1
    s_add_u32 s87, s87, s69
    s_mul_i32 s87, s87, 352
    s_mul_i32 s88, s72, 3
    s_add_u32 s87, s87, s88
    s_add_u32 s87, s87, 40
    s_lshl_b32 s88, s70, 1
    s_add_u32 s88, s88, s87
    s_lshl_b32 s88, s88, 10
    s_add_u32 s87, s87, 1
    s_mul_i32 s93, s70, 176
    s_add_u32 s87, s87, s93
    s_lshl_b32 s87, s87, 10
    v_add_u32 v81, s88, v51
    v_add_u32 v82, s87, v51
    v_pk_mul_f32 v[120:121], v[120:121], v[136:137]
    v_pk_mul_f32 v[122:123], v[122:123], v[138:139]
    v_pk_mul_f32 v[152:153], v[152:153], v[168:169]
    v_pk_mul_f32 v[154:155], v[154:155], v[170:171]
    v_cvt_pk_bf16_f32 v136, v120, v121
    v_cvt_pk_bf16_f32 v137, v122, v123
    v_cvt_pk_bf16_f32 v138, v152, v153
    v_cvt_pk_bf16_f32 v139, v154, v155
    v_add_u32 v120, 0, v81
    global_store_dwordx4 v120, v[136:139], s[36:37] sc1
    v_pk_mul_f32 v[124:125], v[124:125], v[140:141]
    v_pk_mul_f32 v[126:127], v[126:127], v[142:143]
    v_pk_mul_f32 v[156:157], v[156:157], v[172:173]
    v_pk_mul_f32 v[158:159], v[158:159], v[174:175]
    v_cvt_pk_bf16_f32 v140, v124, v125
    v_cvt_pk_bf16_f32 v141, v126, v127
    v_cvt_pk_bf16_f32 v142, v156, v157
    v_cvt_pk_bf16_f32 v143, v158, v159
    v_add_u32 v124, 90112, v81
    global_store_dwordx4 v124, v[140:143], s[36:37] sc1
    v_pk_mul_f32 v[128:129], v[128:129], v[144:145]
    v_pk_mul_f32 v[130:131], v[130:131], v[146:147]
    v_pk_mul_f32 v[160:161], v[160:161], v[176:177]
    v_pk_mul_f32 v[162:163], v[162:163], v[178:179]
    v_cvt_pk_bf16_f32 v144, v128, v129
    v_cvt_pk_bf16_f32 v145, v130, v131
    v_cvt_pk_bf16_f32 v146, v160, v161
    v_cvt_pk_bf16_f32 v147, v162, v163
    v_add_u32 v128, 180224, v81
    global_store_dwordx4 v128, v[144:147], s[36:37] sc1
    v_pk_mul_f32 v[132:133], v[132:133], v[148:149]
    v_pk_mul_f32 v[134:135], v[134:135], v[150:151]
    v_pk_mul_f32 v[164:165], v[164:165], v[180:181]
    v_pk_mul_f32 v[166:167], v[166:167], v[182:183]
    v_cvt_pk_bf16_f32 v148, v132, v133
    v_cvt_pk_bf16_f32 v149, v134, v135
    v_cvt_pk_bf16_f32 v150, v164, v165
    v_cvt_pk_bf16_f32 v151, v166, v167
    v_add_u32 v132, 270336, v81
    global_store_dwordx4 v132, v[148:151], s[36:37] sc1
    v_pk_mul_f32 v[184:185], v[184:185], v[200:201]
    v_pk_mul_f32 v[186:187], v[186:187], v[202:203]
    v_pk_mul_f32 v[188:189], v[188:189], v[204:205]
    v_pk_mul_f32 v[190:191], v[190:191], v[206:207]
    v_pk_mul_f32 v[192:193], v[192:193], v[208:209]
    v_pk_mul_f32 v[194:195], v[194:195], v[210:211]
    v_pk_mul_f32 v[196:197], v[196:197], v[212:213]
    v_pk_mul_f32 v[198:199], v[198:199], v[214:215]
    v_cvt_pk_bf16_f32 v200, v184, v185
    v_cvt_pk_bf16_f32 v201, v186, v187
    v_cvt_pk_bf16_f32 v204, v188, v189
    v_cvt_pk_bf16_f32 v205, v190, v191
    v_cvt_pk_bf16_f32 v208, v192, v193
    v_cvt_pk_bf16_f32 v209, v194, v195
    v_cvt_pk_bf16_f32 v212, v196, v197
    v_cvt_pk_bf16_f32 v213, v198, v199
    s_lshl_b32 s88, s68, 10
    v_lshlrev_b32 v20, 3, v1
    v_add_u32 v21, s88, v20
    ds_write_b64 v21, v[200:201] offset:51200
    ds_write_b64 v21, v[204:205] offset:51712
    v_mfma_f32_16x16x32_bf16 v[216:219], a[0:3], a[40:43], v[216:219]
    v_add_f32_dpp v73, v73, v73 row_shr:8 row_mask:0xf bank_mask:0xf bound_ctrl:0
    v_add_f32_dpp v74, v74, v74 row_shr:8 row_mask:0xf bank_mask:0xf bound_ctrl:0
    v_mfma_f32_16x16x32_bf16 v[220:223], a[4:7], a[40:43], v[220:223]
    v_add_f32_dpp v73, v73, v73 row_bcast:15 row_mask:0xa bank_mask:0xf
    v_add_f32_dpp v74, v74, v74 row_bcast:15 row_mask:0xa bank_mask:0xf
    v_mfma_f32_16x16x32_bf16 v[224:227], a[8:11], a[40:43], v[224:227]
    v_add_f32_dpp v73, v73, v73 row_bcast:31 row_mask:0xc bank_mask:0xf
    v_add_f32_dpp v74, v74, v74 row_bcast:31 row_mask:0xc bank_mask:0xf
    v_mfma_f32_16x16x32_bf16 v[228:231], a[12:15], a[40:43], v[228:231]
    v_readlane_b32 s82, v73, 63
    v_readlane_b32 s83, v74, 63
    v_mfma_f32_16x16x32_bf16 v[232:235], a[0:3], a[44:47], v[232:235]
    v_cmp_eq_u32 vcc, 0, v1
    v_mfma_f32_16x16x32_bf16 v[236:239], a[4:7], a[44:47], v[236:239]
    v_mov_b32 v78, s82
    v_mov_b32 v77, s83
    v_mfma_f32_16x16x32_bf16 v[240:243], a[8:11], a[44:47], v[240:243]
    v_cndmask_b32 v77, v77, v78, vcc
    v_mfma_f32_16x16x32_bf16 v[244:247], a[12:15], a[44:47], v[244:247]
    v_cvt_pk_bf16_f32 v77, v77, v77
    v_mfma_f32_16x16x32_bf16 v[248:251], a[8:11], a[48:51], v[248:251]
    v_lshlrev_b32 v77, 16, v77
    v_mul_f32 v77, 0xbfb8aa3b, v77
    v_mfma_f32_16x16x32_bf16 v[252:255], a[12:15], a[48:51], v[252:255]
    v_exp_f32 v77, v77
    v_mfma_f32_16x16x32_bf16 v[216:219], a[52:55], a[92:95], v[216:219]
    v_add_f32 v77, 1.0, v77
    v_mfma_f32_16x16x32_bf16 v[220:223], a[56:59], a[92:95], v[220:223]
    v_rcp_f32 v77, v77
    v_mfma_f32_16x16x32_bf16 v[224:227], a[60:63], a[92:95], v[224:227]
    v_cvt_pk_bf16_f32 v77, v77, v77
    v_mfma_f32_16x16x32_bf16 v[228:231], a[64:67], a[92:95], v[228:231]
    v_lshlrev_b32 v72, 16, v77
    s_lshl_b32 s82, s94, 2
    v_mfma_f32_16x16x32_bf16 v[232:235], a[52:55], a[96:99], v[232:235]
    s_add_u32 s82, s82, 11534336
    v_mfma_f32_16x16x32_bf16 v[236:239], a[56:59], a[96:99], v[236:239]
    v_lshl_add_u32 v71, v1, 2, s82
    v_mfma_f32_16x16x32_bf16 v[240:243], a[60:63], a[96:99], v[240:243]
    v_mfma_f32_16x16x32_bf16 v[244:247], a[64:67], a[96:99], v[244:247]
    v_mfma_f32_16x16x32_bf16 v[248:251], a[60:63], a[100:103], v[248:251]
    v_mfma_f32_16x16x32_bf16 v[252:255], a[64:67], a[100:103], v[252:255]
    s_mov_b64 exec, 3
    global_store_dword v71, v72, s[36:37] sc1
    s_mov_b64 exec, -1
    s_branch L_epi
L_blk1:
    s_cmp_eq_u32 s77, 1
    s_cbranch_scc1 L_b0_1
    v_lshlrev_b32 v19, 4, v1
    v_add_u32 v19, 11812864, v19
    global_load_dwordx4 v[52:55], v19, s[36:37] sc1
    s_lshl_b32 s88, s71, 7
    s_lshl_b32 s89, s69, 6
    s_add_u32 s88, s88, s89
    s_lshl_b32 s89, s72, 2
    s_add_u32 s88, s88, s89
    s_lshl_b32 s89, s70, 1
    s_add_u32 s94, s88, s89
    s_mul_i32 s88, s94, 1280
    v_lshlrev_b32 v19, 2, v1
    v_add_u32 v20, s88, v51
    v_add_u32 v21, s88, v19
    global_load_dwordx4 v[56:59], v51, s[30:31]
    global_load_dword v60, v19, s[30:31] offset:1024
    global_load_dwordx4 v[62:65], v20, s[4:5]
    global_load_dword v61, v21, s[4:5] offset:1024
    global_load_dwordx4 v[66:69], v20, s[4:5] offset:1280
    global_load_dword v70, v21, s[4:5] offset:2304
    s_branch L_blkr1
L_b0_1:
    s_mov_b32 s95, 0
L_np1:
    v_readfirstlane_b32 s3, v49
    s_cmp_lg_u32 s3, 0
    s_cbranch_scc1 L_nok1
    s_add_u32 s95, s95, 1
    s_cmp_gt_u32 s95, 100000
    s_cbranch_scc1 L_nok1
    v_mov_b32 v19, 0
    global_load_dword v49, v19, s[34:35] sc1
    s_waitcnt vmcnt(0)
    s_branch L_np1
L_nok1:
    s_cmp_lg_u32 s68, 0
    s_cbranch_scc1 L_blkr1
    s_lshl_b32 s88, s2, 2
    s_add_u32 s88, s88, 11812864
    v_mov_b32 v19, s88
    v_mov_b32 v20, s3
    s_mov_b64 exec, 1
    global_store_dword v19, v20, s[36:37] sc1
    s_mov_b64 exec, -1
    s_branch L_blkr1
L_epi:
    s_nop 7
    v_fma_f32 v56, v36, v216, v217
    v_fma_f32 v57, v37, v232, v233
    v_fma_f32 v58, v38, v248, v249
    v_fmac_f32_dpp v56, v216, v39 quad_perm:[1,0,3,2] row_mask:0xf bank_mask:0xf
    v_fmac_f32_dpp v57, v232, v40 quad_perm:[1,0,3,2] row_mask:0xf bank_mask:0xf
    v_fmac_f32_dpp v58, v248, v41 quad_perm:[1,0,3,2] row_mask:0xf bank_mask:0xf
    v_fma_f32 v59, v36, v56, v218
    v_fma_f32 v60, v37, v57, v234
    v_fma_f32 v61, v38, v58, v250
    v_fmac_f32_dpp v59, v56, v39 quad_perm:[1,0,3,2] row_mask:0xf bank_mask:0xf
    v_fmac_f32_dpp v60, v57, v40 quad_perm:[1,0,3,2] row_mask:0xf bank_mask:0xf
    v_fmac_f32_dpp v61, v58, v41 quad_perm:[1,0,3,2] row_mask:0xf bank_mask:0xf
    v_fma_f32 v56, v36, v59, v219
    v_fma_f32 v57, v37, v60, v235
    v_fma_f32 v58, v38, v61, v251
    v_fmac_f32_dpp v56, v59, v39 quad_perm:[1,0,3,2] row_mask:0xf bank_mask:0xf
    v_fmac_f32_dpp v57, v60, v40 quad_perm:[1,0,3,2] row_mask:0xf bank_mask:0xf
    v_fmac_f32_dpp v58, v61, v41 quad_perm:[1,0,3,2] row_mask:0xf bank_mask:0xf
    v_fma_f32 v59, v36, v56, v220
    v_fma_f32 v60, v37, v57, v236
    v_fma_f32 v61, v38, v58, v252
    v_fmac_f32_dpp v59, v56, v39 quad_perm:[1,0,3,2] row_mask:0xf bank_mask:0xf
    v_fmac_f32_dpp v60, v57, v40 quad_perm:[1,0,3,2] row_mask:0xf bank_mask:0xf
    v_fmac_f32_dpp v61, v58, v41 quad_perm:[1,0,3,2] row_mask:0xf bank_mask:0xf
    v_fma_f32 v56, v36, v59, v221
    v_fma_f32 v57, v37, v60, v237
    v_fma_f32 v58, v38, v61, v253
    v_fmac_f32_dpp v56, v59, v39 quad_perm:[1,0,3,2] row_mask:0xf bank_mask:0xf
    v_fmac_f32_dpp v57, v60, v40 quad_perm:[1,0,3,2] row_mask:0xf bank_mask:0xf
    v_fmac_f32_dpp v58, v61, v41 quad_perm:[1,0,3,2] row_mask:0xf bank_mask:0xf
    v_fma_f32 v59, v36, v56, v222
    v_fma_f32 v60, v37, v57, v238
    v_fma_f32 v61, v38, v58, v254
    v_fmac_f32_dpp v59, v56, v39 quad_perm:[1,0,3,2] row_mask:0xf bank_mask:0xf
    v_fmac_f32_dpp v60, v57, v40 quad_perm:[1,0,3,2] row_mask:0xf bank_mask:0xf
    v_fmac_f32_dpp v61, v58, v41 quad_perm:[1,0,3,2] row_mask:0xf bank_mask:0xf
    v_fma_f32 v56, v36, v59, v223
    v_fma_f32 v57, v37, v60, v239
    v_fma_f32 v58, v38, v61, v255
    v_fmac_f32_dpp v56, v59, v39 quad_perm:[1,0,3,2] row_mask:0xf bank_mask:0xf
    v_fmac_f32_dpp v57, v60, v40 quad_perm:[1,0,3,2] row_mask:0xf bank_mask:0xf
    v_fmac_f32_dpp v58, v61, v41 quad_perm:[1,0,3,2] row_mask:0xf bank_mask:0xf
    v_fma_f32 v59, v36, v56, v224
    v_fma_f32 v60, v37, v57, v240
    v_fmac_f32_dpp v59, v56, v39 quad_perm:[1,0,3,2] row_mask:0xf bank_mask:0xf
    v_fmac_f32_dpp v60, v57, v40 quad_perm:[1,0,3,2] row_mask:0xf bank_mask:0xf
    v_fma_f32 v56, v36, v59, v225
    v_fma_f32 v57, v37, v60, v241
    v_fmac_f32_dpp v56, v59, v39 quad_perm:[1,0,3,2] row_mask:0xf bank_mask:0xf
    v_fmac_f32_dpp v57, v60, v40 quad_perm:[1,0,3,2] row_mask:0xf bank_mask:0xf
    v_fma_f32 v59, v36, v56, v226
    v_fma_f32 v60, v37, v57, v242
    v_fmac_f32_dpp v59, v56, v39 quad_perm:[1,0,3,2] row_mask:0xf bank_mask:0xf
    v_fmac_f32_dpp v60, v57, v40 quad_perm:[1,0,3,2] row_mask:0xf bank_mask:0xf
    v_fma_f32 v56, v36, v59, v227
    v_fma_f32 v57, v37, v60, v243
    v_fmac_f32_dpp v56, v59, v39 quad_perm:[1,0,3,2] row_mask:0xf bank_mask:0xf
    v_fmac_f32_dpp v57, v60, v40 quad_perm:[1,0,3,2] row_mask:0xf bank_mask:0xf
    v_fma_f32 v59, v36, v56, v228
    v_fma_f32 v60, v37, v57, v244
    v_fmac_f32_dpp v59, v56, v39 quad_perm:[1,0,3,2] row_mask:0xf bank_mask:0xf
    v_fmac_f32_dpp v60, v57, v40 quad_perm:[1,0,3,2] row_mask:0xf bank_mask:0xf
    v_fma_f32 v56, v36, v59, v229
    v_fma_f32 v57, v37, v60, v245
    v_fmac_f32_dpp v56, v59, v39 quad_perm:[1,0,3,2] row_mask:0xf bank_mask:0xf
    v_fmac_f32_dpp v57, v60, v40 quad_perm:[1,0,3,2] row_mask:0xf bank_mask:0xf
    v_fma_f32 v59, v36, v56, v230
    v_fma_f32 v60, v37, v57, v246
    v_fmac_f32_dpp v59, v56, v39 quad_perm:[1,0,3,2] row_mask:0xf bank_mask:0xf
    v_fmac_f32_dpp v60, v57, v40 quad_perm:[1,0,3,2] row_mask:0xf bank_mask:0xf
    v_fma_f32 v56, v36, v59, v231
    v_fma_f32 v57, v37, v60, v247
    v_fmac_f32_dpp v56, v59, v39 quad_perm:[1,0,3,2] row_mask:0xf bank_mask:0xf
    v_fmac_f32_dpp v57, v60, v40 quad_perm:[1,0,3,2] row_mask:0xf bank_mask:0xf
    s_mul_i32 s87, s68, 320
    s_add_u32 s87, s87, 153600
    v_mul_f32 v62, v42, v56
    v_mul_f32 v63, v43, v57
    v_mul_f32 v64, v44, v58
    v_fmac_f32_dpp v62, v56, v45 quad_perm:[1,0,3,2] row_mask:0xf bank_mask:0xf
    v_fmac_f32_dpp v63, v57, v46 quad_perm:[1,0,3,2] row_mask:0xf bank_mask:0xf
    v_fmac_f32_dpp v64, v58, v47 quad_perm:[1,0,3,2] row_mask:0xf bank_mask:0xf
    v_add_u32 v19, s87, v90
    ds_write_b32 v91, v56 offset:3072
    ds_write_b32 v91, v57 offset:3136
    ds_write_b32 v92, v58 offset:6080
    v_mov_b32 v65, v62
    v_mov_b32 v66, v63
    v_mov_b32 v67, v64
    s_nop 0
    v_permlane16_swap_b32 v62, v65
    v_permlane16_swap_b32 v63, v66
    v_permlane16_swap_b32 v64, v67
    s_nop 0
    v_add_f32 v62, v62, v65
    v_add_f32 v63, v63, v66
    v_add_f32 v64, v64, v67
    v_mov_b32 v65, v62
    v_mov_b32 v66, v63
    v_mov_b32 v67, v64
    s_nop 0
    v_permlane32_swap_b32 v62, v65
    v_permlane32_swap_b32 v63, v66
    v_permlane32_swap_b32 v64, v67
    s_nop 0
    v_add_f32 v62, v62, v65
    v_add_f32 v63, v63, v66
    v_add_f32 v64, v64, v67
    ds_write_b32 v93, v62 offset:0
    ds_write_b32 v93, v63 offset:64
    ds_write_b32 v19, v64 offset:256
    s_waitcnt lgkmcnt(0)
    s_barrier
    s_xor_b32 s88, s68, 1
    s_lshl_b32 s88, s88, 10
    v_lshlrev_b32 v20, 3, v1
    v_add_u32 v21, s88, v20
    v_add_u32 v23, 90112, v82
    s_cmp_eq_u32 s70, 1
    s_cbranch_scc1 L_xr1
    ds_read_b64 v[202:203], v21 offset:51200
    ds_read_b64 v[206:207], v21 offset:51712
    s_waitcnt lgkmcnt(0)
    global_store_dwordx4 v82, v[200:203], s[36:37] sc1
    global_store_dwordx4 v23, v[204:207], s[36:37] sc1
    s_branch L_xr2
L_xr1:
    ds_read_b64 v[192:193], v21 offset:51200
    v_mov_b32 v194, v208
    v_mov_b32 v195, v209
    ds_read_b64 v[196:197], v21 offset:51712
    v_mov_b32 v198, v212
    v_mov_b32 v199, v213
    s_waitcnt lgkmcnt(0)
    global_store_dwordx4 v82, v[192:195], s[36:37] sc1
    global_store_dwordx4 v23, v[196:199], s[36:37] sc1
L_xr2:
    s_cmp_lg_u32 s68, 0
    s_cbranch_scc1 L_nopub
    v_lshlrev_b32 v19, 3, v1
    v_add_u32 v19, 153600, v19
    ds_read_b64 v[68:69], v19 offset:0
    ds_read_b64 v[70:71], v19 offset:320
    ds_read_b64 v[72:73], v19 offset:640
    ds_read_b64 v[74:75], v19 offset:960
    s_lshl_b32 s87, s72, 4
    s_add_u32 s87, s87, s71
    s_mul_i32 s87, s87, 640
    s_add_u32 s87, s87, 11599872
    v_lshlrev_b32 v19, 4, v1
    v_add_u32 v19, s87, v19
    v_mov_b32 v77, s3
    v_mov_b32 v79, s3
    v_cmp_gt_u32 vcc, 40, v1
    s_waitcnt lgkmcnt(0)
    v_pk_add_f32 v[68:69], v[68:69], v[70:71]
    v_pk_add_f32 v[72:73], v[72:73], v[74:75]
    v_pk_add_f32 v[68:69], v[68:69], v[72:73]
    s_and_saveexec_b64 s[38:39], vcc
    v_mov_b32 v76, v68
    v_mov_b32 v78, v69
    global_store_dwordx4 v19, v[76:79], s[36:37] sc1
    s_mov_b64 exec, s[38:39]
L_nopub:
    v_cvt_f32_u32 v152, v50
    v_mul_f32 v152, 0x41800000, v152
    s_lshl_b32 s87, s70, 3
    v_cvt_f32_u32 v155, s87
    v_add_f32 v155, v155, v152
    s_sub_u32 s87, s71, 1
    v_sub_u32 v19, s87, v50
    v_subrev_u32 v20, 8, v19
    v_sub_u32 v21, v19, v50
    v_subrev_u32 v21, s70, v21
    v_cmp_le_i32 vcc, 0, v19
    v_max_i32 v153, 0, v19
    v_cvt_f32_i32 v153, v153
    v_cndmask_b32 v157, 0, 1.0, vcc
    v_mul_f32 v153, 0x43000000, v153
    v_cmp_le_i32 vcc, 0, v20
    v_max_i32 v154, 0, v20
    v_cvt_f32_i32 v154, v154
    v_cndmask_b32 v158, 0, 1.0, vcc
    v_mul_f32 v154, 0x43000000, v154
    v_cmp_le_i32 vcc, 0, v21
    v_max_i32 v156, 0, v21
    v_cvt_f32_i32 v156, v156
    v_cndmask_b32 v159, 0, 1.0, vcc
    v_mul_f32 v156, 0x43000000, v156
    v_mov_b32 v160, 0x41800000
    v_mov_b32 v161, 0x41000000
    v_mul_f32 v164, v160, v24
    v_mul_f32 v170, v160, v25
    v_mul_f32 v176, v161, v26
    v_mul_f32 v165, v160, v27
    v_mul_f32 v171, v160, v28
    v_mul_f32 v177, v161, v29
    v_exp_f32 v164, v164
    v_exp_f32 v170, v170
    v_exp_f32 v176, v176
    v_rndne_f32 v120, v165
    v_rndne_f32 v121, v171
    v_rndne_f32 v122, v177
    v_sub_f32 v165, v165, v120
    v_sub_f32 v171, v171, v121
    v_sub_f32 v177, v177, v122
    v_cos_f32 v120, v165
    v_cos_f32 v121, v171
    v_cos_f32 v122, v177
    v_sin_f32 v123, v165
    v_sin_f32 v124, v171
    v_sin_f32 v125, v177
    v_mul_f32 v120, v164, v120
    v_mul_f32 v121, v170, v121
    v_mul_f32 v122, v176, v122
    v_mul_f32 v164, v48, v164
    v_mul_f32 v170, v48, v170
    v_mul_f32 v176, v48, v176
    v_mul_f32 v123, v164, v123
    v_mul_f32 v124, v170, v124
    v_mul_f32 v125, v176, v125
    v_mul_f32 v167, v48, v39
    v_mul_f32 v173, v48, v40
    v_mul_f32 v179, v48, v41
    v_add_f32 v166, -1.0, v36
    v_add_f32 v172, -1.0, v37
    v_add_f32 v178, -1.0, v38
    v_mul_f32 v164, v30, v30
    v_mul_f32 v170, v31, v31
    v_mul_f32 v176, v32, v32
    v_fmac_f32 v164, v33, v33
    v_fmac_f32 v170, v34, v34
    v_fmac_f32 v176, v35, v35
    v_rcp_f32 v164, v164
    v_rcp_f32 v170, v170
    v_rcp_f32 v176, v176
    v_mul_f32 v168, v166, v30
    v_mul_f32 v174, v172, v31
    v_mul_f32 v180, v178, v32
    v_fmac_f32 v168, v167, v33
    v_fmac_f32 v174, v173, v34
    v_fmac_f32 v180, v179, v35
    v_mul_f32 v169, v167, v30
    v_mul_f32 v175, v173, v31
    v_mul_f32 v181, v179, v32
    v_fma_f32 v169, -v166, v33, v169
    v_fma_f32 v175, -v172, v34, v175
    v_fma_f32 v181, -v178, v35, v181
    v_add_f32 v164, v164, v164
    v_add_f32 v170, v170, v170
    v_add_f32 v176, v176, v176
    v_mul_f32 v168, v164, v168
    v_mul_f32 v174, v170, v174
    v_mul_f32 v180, v176, v180
    v_mul_f32 v169, v164, v169
    v_mul_f32 v175, v170, v175
    v_mul_f32 v181, v176, v181
    v_mul_f32_e64 v126, -v48, v168
    v_mul_f32_e64 v127, -v48, v174
    v_mul_f32_e64 v128, -v48, v180
    v_sub_f32 v129, 0, v169
    v_sub_f32 v130, 0, v175
    v_sub_f32 v131, 0, v181
    v_sub_f32 v148, 0, v39
    v_sub_f32 v149, 0, v40
    v_sub_f32 v150, 0, v41
    v_mul_f32 v164, v152, v24
    v_mul_f32 v170, v152, v25
    v_mul_f32 v176, v155, v26
    v_mul_f32 v165, v152, v27
    v_mul_f32 v171, v152, v28
    v_mul_f32 v177, v155, v29
    v_exp_f32 v164, v164
    v_exp_f32 v170, v170
    v_exp_f32 v176, v176
    v_rndne_f32 v166, v165
    v_rndne_f32 v172, v171
    v_rndne_f32 v178, v177
    v_sub_f32 v165, v165, v166
    v_sub_f32 v171, v171, v172
    v_sub_f32 v177, v177, v178
    v_cos_f32 v166, v165
    v_cos_f32 v172, v171
    v_cos_f32 v178, v177
    v_sin_f32 v167, v165
    v_sin_f32 v173, v171
    v_sin_f32 v179, v177
    v_mul_f32 v166, v164, v166
    v_mul_f32 v172, v170, v172
    v_mul_f32 v178, v176, v178
    v_mul_f32 v167, v164, v167
    v_mul_f32 v173, v170, v173
    v_mul_f32 v179, v176, v179
    v_mul_f32 v132, v168, v166
    v_mul_f32 v133, v174, v172
    v_mul_f32 v134, v180, v178
    v_fma_f32 v132, -v169, v167, v132
    v_fma_f32 v133, -v175, v173, v133
    v_fma_f32 v134, -v181, v179, v134
    v_mul_f32 v135, v168, v167
    v_mul_f32 v136, v174, v173
    v_mul_f32 v137, v180, v179
    v_fmac_f32 v135, v169, v166
    v_fmac_f32 v136, v175, v172
    v_fmac_f32 v137, v181, v178
    v_mul_f32_e64 v132, -v48, v132
    v_mul_f32_e64 v133, -v48, v133
    v_mul_f32_e64 v134, -v48, v134
    v_sub_f32 v135, 0, v135
    v_sub_f32 v136, 0, v136
    v_sub_f32 v137, 0, v137
    v_mul_f32 v164, v153, v24
    v_mul_f32 v170, v153, v25
    v_mul_f32 v176, v156, v26
    v_mul_f32 v165, v153, v27
    v_mul_f32 v171, v153, v28
    v_mul_f32 v177, v156, v29
    v_exp_f32 v164, v164
    v_exp_f32 v170, v170
    v_exp_f32 v176, v176
    v_rndne_f32 v138, v165
    v_rndne_f32 v139, v171
    v_rndne_f32 v140, v177
    v_sub_f32 v165, v165, v138
    v_sub_f32 v171, v171, v139
    v_sub_f32 v177, v177, v140
    v_cos_f32 v138, v165
    v_cos_f32 v139, v171
    v_cos_f32 v140, v177
    v_sin_f32 v141, v165
    v_sin_f32 v142, v171
    v_sin_f32 v143, v177
    v_mul_f32 v138, v164, v138
    v_mul_f32 v139, v170, v139
    v_mul_f32 v140, v176, v140
    v_mul_f32 v164, v48, v164
    v_mul_f32 v170, v48, v170
    v_mul_f32 v176, v48, v176
    v_mul_f32 v141, v164, v141
    v_mul_f32 v142, v170, v142
    v_mul_f32 v143, v176, v143
    v_mul_f32 v138, v157, v138
    v_mul_f32 v139, v157, v139
    v_mul_f32 v140, v159, v140
    v_mul_f32 v141, v157, v141
    v_mul_f32 v142, v157, v142
    v_mul_f32 v143, v159, v143
    v_mul_f32 v164, v154, v24
    v_mul_f32 v170, v154, v25
    v_mul_f32 v165, v154, v27
    v_mul_f32 v171, v154, v28
    v_exp_f32 v164, v164
    v_exp_f32 v170, v170
    v_rndne_f32 v144, v165
    v_rndne_f32 v145, v171
    v_sub_f32 v165, v165, v144
    v_sub_f32 v171, v171, v145
    v_cos_f32 v144, v165
    v_cos_f32 v145, v171
    v_sin_f32 v146, v165
    v_sin_f32 v147, v171
    v_mul_f32 v144, v164, v144
    v_mul_f32 v145, v170, v145
    v_mul_f32 v164, v48, v164
    v_mul_f32 v170, v48, v170
    v_mul_f32 v146, v164, v146
    v_mul_f32 v147, v170, v147
    v_mul_f32 v144, v158, v144
    v_mul_f32 v145, v158, v145
    v_mul_f32 v146, v158, v146
    v_mul_f32 v147, v158, v147
    s_waitcnt vmcnt(0)
    s_lshl_b32 s87, s71, 1
    s_add_u32 s87, s87, s69
    s_lshl_b32 s87, s87, 4
    s_add_u32 s87, s87, s72
    s_lshl_b32 s87, s87, 1
    s_add_u32 s87, s87, s70
    s_lshl_b32 s87, s87, 2
    s_add_u32 s87, s87, 11796480
    v_mov_b32 v18, s87
    v_mov_b32 v19, s3
    s_mov_b64 exec, 1
    global_store_dword v18, v19, s[36:37] sc1
    s_mov_b64 exec, -1
    s_lshl_b32 s87, s91, 7
    s_lshl_b32 s88, s68, 5
    s_add_u32 s87, s87, s88
    v_and_b32 v24, 7, v1
    v_lshlrev_b32 v24, 2, v24
    v_add_u32 v24, s87, v24
    v_add_u32 v24, 11796480, v24
    s_mov_b32 s44, s36
    s_mov_b32 s45, s37
    s_mov_b32 s46, 11534336
    s_mov_b32 s47, 0x00020000
    s_mov_b32 s64, s36
    s_mov_b32 s65, s37
    s_mov_b32 s66, 11763712
    s_mov_b32 s67, 0x00020000
    buffer_load_dwordx2 v[70:71], v94, s[64:67], 0 offen sc1
    buffer_load_dwordx2 v[72:73], v94, s[64:67], 0 offen offset:128 sc1
    buffer_load_dwordx2 v[74:75], v95, s[64:67], 0 offen sc1
    buffer_load_dwordx2 v[76:77], v95, s[64:67], 0 offen offset:128 sc1
    buffer_load_dwordx2 v[78:79], v96, s[64:67], 0 offen sc1
    buffer_load_dwordx4 a[0:3], v51, s[40:43], s78 offen sc1
    v_subrev_u32 v19, 256, v91
    ds_read_b32 v184, v19 offset:3072
    ds_read_b32 v185, v19 offset:2816
    ds_read_b32 v186, v19 offset:2560
    ds_read_b32 v187, v19 offset:2304
    ds_read_b32 v188, v19 offset:2048
    ds_read_b32 v189, v19 offset:1792
    ds_read_b32 v190, v19 offset:1536
    ds_read_b32 v191, v19 offset:3136
    ds_read_b32 v192, v19 offset:2880
    ds_read_b32 v193, v19 offset:2624
    buffer_load_dwordx4 a[4:7], v51, s[40:43], s78 offen offset:1024 sc1
    ds_read_b32 v194, v19 offset:2368
    ds_read_b32 v195, v19 offset:2112
    ds_read_b32 v196, v19 offset:1856
    ds_read_b32 v197, v19 offset:1600
    v_subrev_u32 v20, 64, v92
    ds_read_b32 v198, v20 offset:6080
    ds_read_b32 v199, v20 offset:6016
    ds_read_b32 v200, v20 offset:5952
    ds_read_b32 v201, v20 offset:5888
    ds_read_b32 v202, v20 offset:5824
    ds_read_b32 v203, v20 offset:5760
    buffer_load_dwordx4 a[8:11], v51, s[40:43], s78 offen offset:2048 sc1
    ds_read_b32 v204, v20 offset:5696
    ds_read_b32 v205, v20 offset:5632
    ds_read_b32 v206, v20 offset:5568
    ds_read_b32 v207, v20 offset:5504
    ds_read_b32 v208, v20 offset:5440
    ds_read_b32 v209, v20 offset:5376
    ds_read_b32 v210, v20 offset:5312
    ds_read_b32 v211, v20 offset:5248
    ds_read_b32 v212, v20 offset:5184
    v_mul_f32 v56, v126, v216
    v_mul_f32 v57, v127, v232
    buffer_load_dwordx4 a[12:15], v51, s[40:43], s78 offen offset:3072 sc1
    v_mul_f32 v58, v128, v248
    v_fmac_f32_dpp v56, v216, v129 quad_perm:[1,0,3,2] row_mask:0xf bank_mask:0xf
    v_fmac_f32_dpp v57, v232, v130 quad_perm:[1,0,3,2] row_mask:0xf bank_mask:0xf
    v_fmac_f32_dpp v58, v248, v131 quad_perm:[1,0,3,2] row_mask:0xf bank_mask:0xf
    v_mov_b32 v216, v56
    v_mov_b32 v232, v57
    v_mov_b32 v248, v58
    v_mul_f32 v56, v126, v217
    v_mul_f32 v57, v127, v233
    v_mul_f32 v58, v128, v249
    v_fmac_f32_dpp v56, v217, v129 quad_perm:[1,0,3,2] row_mask:0xf bank_mask:0xf
    buffer_load_dwordx4 a[16:19], v51, s[40:43], s79 offen sc1
    s_add_u32 s78, s78, 5120
    s_add_u32 s79, s79, 5120
    v_fmac_f32_dpp v57, v233, v130 quad_perm:[1,0,3,2] row_mask:0xf bank_mask:0xf
    v_fmac_f32_dpp v58, v249, v131 quad_perm:[1,0,3,2] row_mask:0xf bank_mask:0xf
    v_mov_b32 v217, v56
    v_mov_b32 v233, v57
    v_mov_b32 v249, v58
    v_mul_f32 v56, v126, v218
    v_mul_f32 v57, v127, v234
    v_mul_f32 v58, v128, v250
    v_fmac_f32_dpp v56, v218, v129 quad_perm:[1,0,3,2] row_mask:0xf bank_mask:0xf
    v_fmac_f32_dpp v57, v234, v130 quad_perm:[1,0,3,2] row_mask:0xf bank_mask:0xf
    v_fmac_f32_dpp v58, v250, v131 quad_perm:[1,0,3,2] row_mask:0xf bank_mask:0xf
    buffer_load_dwordx4 a[20:23], v51, s[40:43], s78 offen sc1
    v_mov_b32 v218, v56
    v_mov_b32 v234, v57
    v_mov_b32 v250, v58
    v_mul_f32 v56, v126, v219
    v_mul_f32 v57, v127, v235
    v_mul_f32 v58, v128, v251
    v_fmac_f32_dpp v56, v219, v129 quad_perm:[1,0,3,2] row_mask:0xf bank_mask:0xf
    v_fmac_f32_dpp v57, v235, v130 quad_perm:[1,0,3,2] row_mask:0xf bank_mask:0xf
    v_fmac_f32_dpp v58, v251, v131 quad_perm:[1,0,3,2] row_mask:0xf bank_mask:0xf
    v_mov_b32 v219, v56
    v_mov_b32 v235, v57
    buffer_load_dwordx4 a[24:27], v51, s[40:43], s78 offen offset:1024 sc1
    v_mov_b32 v251, v58
    v_mul_f32 v56, v126, v220
    v_mul_f32 v57, v127, v236
    v_mul_f32 v58, v128, v252
    v_fmac_f32_dpp v56, v220, v129 quad_perm:[1,0,3,2] row_mask:0xf bank_mask:0xf
    v_fmac_f32_dpp v57, v236, v130 quad_perm:[1,0,3,2] row_mask:0xf bank_mask:0xf
    v_fmac_f32_dpp v58, v252, v131 quad_perm:[1,0,3,2] row_mask:0xf bank_mask:0xf
    v_mov_b32 v220, v56
    v_mov_b32 v236, v57
    v_mov_b32 v252, v58
    v_mul_f32 v56, v126, v221
    buffer_load_dwordx4 a[28:31], v51, s[40:43], s78 offen offset:2048 sc1
    v_mul_f32 v57, v127, v237
    v_mul_f32 v58, v128, v253
    v_fmac_f32_dpp v56, v221, v129 quad_perm:[1,0,3,2] row_mask:0xf bank_mask:0xf
    v_fmac_f32_dpp v57, v237, v130 quad_perm:[1,0,3,2] row_mask:0xf bank_mask:0xf
    v_fmac_f32_dpp v58, v253, v131 quad_perm:[1,0,3,2] row_mask:0xf bank_mask:0xf
    v_mov_b32 v221, v56
    v_mov_b32 v237, v57
    v_mov_b32 v253, v58
    v_mul_f32 v56, v126, v222
    v_mul_f32 v57, v127, v238
    v_mul_f32 v58, v128, v254
    buffer_load_dwordx4 a[32:35], v51, s[40:43], s78 offen offset:3072 sc1
    v_fmac_f32_dpp v56, v222, v129 quad_perm:[1,0,3,2] row_mask:0xf bank_mask:0xf
    v_fmac_f32_dpp v57, v238, v130 quad_perm:[1,0,3,2] row_mask:0xf bank_mask:0xf
    v_fmac_f32_dpp v58, v254, v131 quad_perm:[1,0,3,2] row_mask:0xf bank_mask:0xf
    v_mov_b32 v222, v56
    v_mov_b32 v238, v57
    v_mov_b32 v254, v58
    v_mul_f32 v56, v126, v223
    v_mul_f32 v57, v127, v239
    v_mul_f32 v58, v128, v255
    v_fmac_f32_dpp v56, v223, v129 quad_perm:[1,0,3,2] row_mask:0xf bank_mask:0xf
    v_fmac_f32_dpp v57, v239, v130 quad_perm:[1,0,3,2] row_mask:0xf bank_mask:0xf
    buffer_load_dwordx4 a[36:39], v51, s[40:43], s79 offen sc1
    s_add_u32 s78, s78, 5120
    s_add_u32 s79, s79, 5120
    v_fmac_f32_dpp v58, v255, v131 quad_perm:[1,0,3,2] row_mask:0xf bank_mask:0xf
    v_mov_b32 v223, v56
    v_mov_b32 v239, v57
    v_mov_b32 v255, v58
    v_mul_f32 v56, v126, v224
    v_mul_f32 v57, v127, v240
    v_fmac_f32_dpp v56, v224, v129 quad_perm:[1,0,3,2] row_mask:0xf bank_mask:0xf
    v_fmac_f32_dpp v57, v240, v130 quad_perm:[1,0,3,2] row_mask:0xf bank_mask:0xf
    v_mov_b32 v224, v56
    v_mov_b32 v240, v57
    v_mul_f32 v56, v126, v225
    buffer_load_dwordx4 a[40:43], v51, s[40:43], s78 offen sc1
    v_mul_f32 v57, v127, v241
    v_fmac_f32_dpp v56, v225, v129 quad_perm:[1,0,3,2] row_mask:0xf bank_mask:0xf
    v_fmac_f32_dpp v57, v241, v130 quad_perm:[1,0,3,2] row_mask:0xf bank_mask:0xf
    v_mov_b32 v225, v56
    v_mov_b32 v241, v57
    v_mul_f32 v56, v126, v226
    v_mul_f32 v57, v127, v242
    v_fmac_f32_dpp v56, v226, v129 quad_perm:[1,0,3,2] row_mask:0xf bank_mask:0xf
    v_fmac_f32_dpp v57, v242, v130 quad_perm:[1,0,3,2] row_mask:0xf bank_mask:0xf
    v_mov_b32 v226, v56
    v_mov_b32 v242, v57
    buffer_load_dwordx4 a[44:47], v51, s[40:43], s78 offen offset:1024 sc1
    v_mul_f32 v56, v126, v227
    v_mul_f32 v57, v127, v243
    v_fmac_f32_dpp v56, v227, v129 quad_perm:[1,0,3,2] row_mask:0xf bank_mask:0xf
    v_fmac_f32_dpp v57, v243, v130 quad_perm:[1,0,3,2] row_mask:0xf bank_mask:0xf
    v_mov_b32 v227, v56
    v_mov_b32 v243, v57
    v_mul_f32 v56, v126, v228
    v_mul_f32 v57, v127, v244
    v_fmac_f32_dpp v56, v228, v129 quad_perm:[1,0,3,2] row_mask:0xf bank_mask:0xf
    v_fmac_f32_dpp v57, v244, v130 quad_perm:[1,0,3,2] row_mask:0xf bank_mask:0xf
    v_mov_b32 v228, v56
    buffer_load_dwordx4 a[48:51], v51, s[40:43], s78 offen offset:2048 sc1
    v_mov_b32 v244, v57
    v_mul_f32 v56, v126, v229
    v_mul_f32 v57, v127, v245
    v_fmac_f32_dpp v56, v229, v129 quad_perm:[1,0,3,2] row_mask:0xf bank_mask:0xf
    v_fmac_f32_dpp v57, v245, v130 quad_perm:[1,0,3,2] row_mask:0xf bank_mask:0xf
    v_mov_b32 v229, v56
    v_mov_b32 v245, v57
    v_mul_f32 v56, v126, v230
    v_mul_f32 v57, v127, v246
    v_fmac_f32_dpp v56, v230, v129 quad_perm:[1,0,3,2] row_mask:0xf bank_mask:0xf
    v_fmac_f32_dpp v57, v246, v130 quad_perm:[1,0,3,2] row_mask:0xf bank_mask:0xf
    v_mov_b32 v230, v56
    buffer_load_dwordx4 a[52:55], v51, s[40:43], s78 offen offset:3072 sc1
    v_mov_b32 v246, v57
    v_mul_f32 v56, v126, v231
    v_mul_f32 v57, v127, v247
    v_fmac_f32_dpp v56, v231, v129 quad_perm:[1,0,3,2] row_mask:0xf bank_mask:0xf
    v_fmac_f32_dpp v57, v247, v130 quad_perm:[1,0,3,2] row_mask:0xf bank_mask:0xf
    v_mov_b32 v231, v56
    v_mov_b32 v247, v57
    s_waitcnt lgkmcnt(0)
    v_fma_f32 v60, v120, v190, v189
    v_fma_f32 v62, v121, v197, v196
    v_fma_f32 v64, v122, v212, v211
    buffer_load_dwordx4 a[56:59], v51, s[40:43], s79 offen sc1
    s_add_u32 s78, s78, 5120
    s_add_u32 s79, s79, 5120
    v_fmac_f32_dpp v60, v190, v123 quad_perm:[1,0,3,2] row_mask:0xf bank_mask:0xf
    v_fmac_f32_dpp v62, v197, v124 quad_perm:[1,0,3,2] row_mask:0xf bank_mask:0xf
    v_fmac_f32_dpp v64, v212, v125 quad_perm:[1,0,3,2] row_mask:0xf bank_mask:0xf
    v_fma_f32 v59, v120, v60, v188
    v_fma_f32 v61, v121, v62, v195
    v_fma_f32 v63, v122, v64, v210
    v_fmac_f32_dpp v59, v60, v123 quad_perm:[1,0,3,2] row_mask:0xf bank_mask:0xf
    v_fmac_f32_dpp v61, v62, v124 quad_perm:[1,0,3,2] row_mask:0xf bank_mask:0xf
    v_fmac_f32_dpp v63, v64, v125 quad_perm:[1,0,3,2] row_mask:0xf bank_mask:0xf
    v_fma_f32 v60, v120, v59, v187
    v_fma_f32 v62, v121, v61, v194
    buffer_load_dwordx4 a[60:63], v51, s[40:43], s78 offen sc1
    v_fma_f32 v64, v122, v63, v209
    v_fmac_f32_dpp v60, v59, v123 quad_perm:[1,0,3,2] row_mask:0xf bank_mask:0xf
    v_fmac_f32_dpp v62, v61, v124 quad_perm:[1,0,3,2] row_mask:0xf bank_mask:0xf
    v_fmac_f32_dpp v64, v63, v125 quad_perm:[1,0,3,2] row_mask:0xf bank_mask:0xf
    v_fma_f32 v59, v120, v60, v186
    v_fma_f32 v61, v121, v62, v193
    v_fma_f32 v63, v122, v64, v208
    v_fmac_f32_dpp v59, v60, v123 quad_perm:[1,0,3,2] row_mask:0xf bank_mask:0xf
    v_fmac_f32_dpp v61, v62, v124 quad_perm:[1,0,3,2] row_mask:0xf bank_mask:0xf
    v_fmac_f32_dpp v63, v64, v125 quad_perm:[1,0,3,2] row_mask:0xf bank_mask:0xf
    v_fma_f32 v60, v120, v59, v185
    buffer_load_dwordx4 a[64:67], v51, s[40:43], s78 offen offset:1024 sc1
    v_fma_f32 v62, v121, v61, v192
    v_fma_f32 v64, v122, v63, v207
    v_fmac_f32_dpp v60, v59, v123 quad_perm:[1,0,3,2] row_mask:0xf bank_mask:0xf
    v_fmac_f32_dpp v62, v61, v124 quad_perm:[1,0,3,2] row_mask:0xf bank_mask:0xf
    v_fmac_f32_dpp v64, v63, v125 quad_perm:[1,0,3,2] row_mask:0xf bank_mask:0xf
    v_fma_f32 v59, v120, v60, v184
    v_fma_f32 v61, v121, v62, v191
    v_fma_f32 v63, v122, v64, v206
    v_fmac_f32_dpp v59, v60, v123 quad_perm:[1,0,3,2] row_mask:0xf bank_mask:0xf
    v_fmac_f32_dpp v61, v62, v124 quad_perm:[1,0,3,2] row_mask:0xf bank_mask:0xf
    v_fmac_f32_dpp v63, v64, v125 quad_perm:[1,0,3,2] row_mask:0xf bank_mask:0xf
    buffer_load_dwordx4 a[68:71], v51, s[40:43], s78 offen offset:2048 sc1
    v_fma_f32 v64, v122, v63, v205
    s_nop 0
    v_fmac_f32_dpp v64, v63, v125 quad_perm:[1,0,3,2] row_mask:0xf bank_mask:0xf
    s_nop 0
    v_fma_f32 v63, v122, v64, v204
    s_nop 0
    v_fmac_f32_dpp v63, v64, v125 quad_perm:[1,0,3,2] row_mask:0xf bank_mask:0xf
    s_nop 0
    v_fma_f32 v64, v122, v63, v203
    s_nop 0
    v_fmac_f32_dpp v64, v63, v125 quad_perm:[1,0,3,2] row_mask:0xf bank_mask:0xf
    buffer_load_dwordx4 a[72:75], v51, s[40:43], s78 offen offset:3072 sc1
    s_nop 0
    v_fma_f32 v63, v122, v64, v202
    s_nop 0
    v_fmac_f32_dpp v63, v64, v125 quad_perm:[1,0,3,2] row_mask:0xf bank_mask:0xf
    s_nop 0
    v_fma_f32 v64, v122, v63, v201
    s_nop 0
    v_fmac_f32_dpp v64, v63, v125 quad_perm:[1,0,3,2] row_mask:0xf bank_mask:0xf
    s_nop 0
    v_fma_f32 v63, v122, v64, v200
    s_nop 0
    buffer_load_dwordx4 a[76:79], v51, s[40:43], s79 offen sc1
    s_add_u32 s78, s78, 5120
    s_add_u32 s79, s79, 5120
    v_fmac_f32_dpp v63, v64, v125 quad_perm:[1,0,3,2] row_mask:0xf bank_mask:0xf
    s_nop 0
    v_fma_f32 v64, v122, v63, v199
    s_nop 0
    v_fmac_f32_dpp v64, v63, v125 quad_perm:[1,0,3,2] row_mask:0xf bank_mask:0xf
    s_nop 0
    v_fma_f32 v63, v122, v64, v198
    s_nop 0
    v_fmac_f32_dpp v63, v64, v125 quad_perm:[1,0,3,2] row_mask:0xf bank_mask:0xf
    s_nop 0
    s_nop 1
    global_load_dword v80, v24, s[36:37] sc1
    v_mul_f32 v4, v126, v59
    v_mul_f32 v5, v127, v61
    v_mul_f32 v6, v128, v63
    v_fmac_f32_dpp v4, v59, v129 quad_perm:[1,0,3,2] row_mask:0xf bank_mask:0xf
    v_fmac_f32_dpp v5, v61, v130 quad_perm:[1,0,3,2] row_mask:0xf bank_mask:0xf
    v_fmac_f32_dpp v6, v63, v131 quad_perm:[1,0,3,2] row_mask:0xf bank_mask:0xf
    v_mov_b32 v7, v97
    v_mov_b32 v8, v98
    v_and_b32 v19, 15, v1
    v_lshrrev_b32 v20, 2, v19
    v_lshlrev_b32 v20, 1, v20
    buffer_load_dwordx4 a[80:83], v51, s[40:43], s78 offen sc1
    v_add_u32 v20, s70, v20
    v_mul_u32_u24 v20, 272, v20
    v_and_b32 v21, 3, v19
    v_lshlrev_b32 v21, 2, v21
    v_lshrrev_b32 v22, 4, v1
    v_add_u32 v21, v21, v22
    s_lshl_b32 s87, s69, 4
    v_add_u32 v21, s87, v21
    v_lshl_add_u32 v2, v21, 3, v20
    s_lshl_b32 s87, s71, 1
    s_add_u32 s87, s87, s69
    buffer_load_dwordx4 a[84:87], v51, s[40:43], s78 offen offset:1024 sc1
    s_lshl_b32 s87, s87, 2
    v_add_u32 v22, s87, v22
    v_mul_u32_u24 v22, 88, v22
    s_mul_i32 s87, s70, 20
    v_add_u32 v22, s87, v22
    v_lshlrev_b32 v22, 10, v22
    v_lshl_add_u32 v3, v19, 4, v22
    s_mul_i32 s87, s72, 5
    s_add_u32 s87, s87, 0
    s_lshr_b32 s88, s87, 2
    s_lshl_b32 s88, s88, 10
    buffer_load_dwordx4 a[244:247], v51, s[40:43], s78 offen offset:2048 sc1
    s_and_b32 s87, s87, 3
    s_lshl_b32 s87, s87, 8
    s_add_u32 s73, s87, s88
    s_mul_i32 s87, s72, 5
    s_add_u32 s87, s87, 1
    s_lshr_b32 s88, s87, 2
    s_lshl_b32 s88, s88, 10
    s_and_b32 s87, s87, 3
    s_lshl_b32 s87, s87, 8
    s_add_u32 s74, s87, s88
    s_mul_i32 s87, s72, 5
    buffer_load_dwordx4 a[248:251], v51, s[40:43], s78 offen offset:3072 sc1
    s_add_u32 s87, s87, 2
    s_lshr_b32 s88, s87, 2
    s_lshl_b32 s88, s88, 10
    s_and_b32 s87, s87, 3
    s_lshl_b32 s87, s87, 8
    s_add_u32 s75, s87, s88
    s_mul_i32 s87, s72, 5
    s_add_u32 s87, s87, 3
    s_lshr_b32 s88, s87, 2
    s_lshl_b32 s88, s88, 10
    s_and_b32 s87, s87, 3
    buffer_load_dwordx4 a[252:255], v51, s[40:43], s79 offen sc1
    s_add_u32 s78, s78, 5120
    s_add_u32 s79, s79, 5120
    s_lshl_b32 s87, s87, 8
    s_add_u32 s76, s87, s88
    s_mul_i32 s87, s72, 5
    s_add_u32 s87, s87, 4
    s_lshr_b32 s88, s87, 2
    s_lshl_b32 s88, s88, 10
    s_and_b32 s87, s87, 3
    s_lshl_b32 s87, s87, 8
    s_add_u32 s77, s87, s88
    s_mul_i32 s80, s68, 12
    s_add_u32 s80, s80, 40
    s_lshl_b32 s80, s80, 10
    s_waitcnt vmcnt(5)
    s_mov_b32 s95, 0
L_fbpoll:
    v_cmp_ne_u32 vcc, s3, v80
    s_nop 4
    s_cbranch_vccz L_fbx
    s_add_u32 s95, s95, 1
    s_cmp_gt_u32 s95, 100000
    s_cbranch_scc1 L_fbx
    global_load_dword v80, v24, s[36:37] sc1
    s_waitcnt vmcnt(0)
    s_branch L_fbpoll
L_fbx:
    buffer_load_dwordx4 a[88:91], v116, s[44:47], s80 offen sc1
    buffer_load_dwordx4 a[92:95], v117, s[44:47], s80 offen sc1
    buffer_load_dwordx4 a[96:99], v118, s[44:47], s80 offen sc1
    buffer_load_dwordx4 a[100:103], v119, s[44:47], s80 offen sc1
    s_add_u32 s80, s80, 1024
    buffer_load_dwordx4 v[100:103], v116, s[44:47], s80 offen sc1
    buffer_load_dwordx4 v[104:107], v117, s[44:47], s80 offen sc1
    buffer_load_dwordx4 v[108:111], v118, s[44:47], s80 offen sc1
    buffer_load_dwordx4 v[112:115], v119, s[44:47], s80 offen sc1
    s_add_u32 s80, s80, 1024
    s_mov_b32 s95, 0
    s_branch L_pollc
L_poll:
    s_add_u32 s95, s95, 1
    s_cmp_gt_u32 s95, 100000
    s_cbranch_scc1 L_pollx
    buffer_load_dwordx2 v[70:71], v94, s[64:67], 0 offen sc1
    buffer_load_dwordx2 v[72:73], v94, s[64:67], 0 offen offset:128 sc1
    buffer_load_dwordx2 v[74:75], v95, s[64:67], 0 offen sc1
    buffer_load_dwordx2 v[76:77], v95, s[64:67], 0 offen offset:128 sc1
    buffer_load_dwordx2 v[78:79], v96, s[64:67], 0 offen sc1
    s_waitcnt vmcnt(0)
L_pollc:
    v_mov_b32 v68, 0
    v_cmp_ne_u32 vcc, s3, v71
    s_nop 1
    v_cndmask_b32 v19, 0, v157, vcc
    v_or_b32 v68, v68, v19
    v_cmp_ne_u32 vcc, s3, v73
    s_nop 1
    v_cndmask_b32 v19, 0, v157, vcc
    v_or_b32 v68, v68, v19
    v_cmp_ne_u32 vcc, s3, v75
    s_nop 1
    v_cndmask_b32 v19, 0, v158, vcc
    v_or_b32 v68, v68, v19
    v_cmp_ne_u32 vcc, s3, v77
    s_nop 1
    v_cndmask_b32 v19, 0, v158, vcc
    v_or_b32 v68, v68, v19
    v_cmp_ne_u32 vcc, s3, v79
    s_nop 1
    v_cndmask_b32 v19, 0, v159, vcc
    v_or_b32 v68, v68, v19
    v_cmp_ne_u32 vcc, 0, v68
    s_nop 4
    s_cbranch_vccnz L_poll
L_pollx:
    v_mul_f32 v65, v138, v70
    v_mul_f32 v66, v139, v72
    v_mul_f32 v67, v140, v78
    v_fmac_f32_dpp v65, v70, v141 quad_perm:[1,0,3,2] row_mask:0xf bank_mask:0xf
    v_fmac_f32_dpp v66, v72, v142 quad_perm:[1,0,3,2] row_mask:0xf bank_mask:0xf
    v_fmac_f32_dpp v67, v78, v143 quad_perm:[1,0,3,2] row_mask:0xf bank_mask:0xf
    v_fmac_f32 v65, v144, v74
    v_fmac_f32 v66, v145, v76
    v_fmac_f32_dpp v65, v74, v146 quad_perm:[1,0,3,2] row_mask:0xf bank_mask:0xf
    v_fmac_f32_dpp v66, v76, v147 quad_perm:[1,0,3,2] row_mask:0xf bank_mask:0xf
    v_mov_b32 v56, v65
    v_mov_b32 v57, v66
    v_mov_b32 v58, v67
    s_nop 0
    v_permlane16_swap_b32 v65, v56
    v_permlane16_swap_b32 v66, v57
    v_permlane16_swap_b32 v67, v58
    s_nop 0
    v_add_f32 v65, v65, v56
    v_add_f32 v66, v66, v57
    v_add_f32 v67, v67, v58
    v_mov_b32 v56, v65
    v_mov_b32 v57, v66
    v_mov_b32 v58, v67
    s_nop 0
    v_permlane32_swap_b32 v65, v56
    v_permlane32_swap_b32 v66, v57
    v_permlane32_swap_b32 v67, v58
    s_nop 0
    v_add_f32 v65, v65, v56
    v_add_f32 v66, v66, v57
    v_add_f32 v67, v67, v58
    s_mul_i32 s87, s68, 320
    s_add_u32 s87, s87, 153600
    v_add_u32 v19, s87, v90
    ds_write_b32 v93, v65 offset:7104
    ds_write_b32 v93, v66 offset:7168
    ds_write_b32 v19, v67 offset:7360
    s_waitcnt lgkmcnt(0)
    s_barrier
    s_mul_i32 s87, s70, 320
    s_add_u32 s87, s87, 153600
    v_add_u32 v19, s87, v7
    ds_read_b32 v160, v19 offset:7104
    ds_read_b32 v161, v19 offset:7744
    ds_read_b32 v162, v19 offset:7168
    ds_read_b32 v163, v19 offset:7808
    ds_read_b32 v164, v8 offset:7360
    ds_read_b32 v165, v8 offset:7680
    ds_read_b32 v166, v8 offset:8000
    ds_read_b32 v167, v8 offset:8320
    s_waitcnt lgkmcnt(0)
    v_add_f32 v168, v160, v161
    v_add_f32 v169, v162, v163
    v_add_f32 v164, v164, v165
    v_add_f32 v166, v166, v167
    v_add_f32 v170, v164, v166
    v_fmac_f32 v4, v132, v168
    buffer_load_dwordx4 v[52:55], v116, s[44:47], s80 offen sc1
    v_fmac_f32 v5, v133, v169
    v_fmac_f32 v6, v134, v170
    s_nop 0
    v_fmac_f32_dpp v4, v168, v135 quad_perm:[1,0,3,2] row_mask:0xf bank_mask:0xf
    v_fmac_f32_dpp v5, v169, v136 quad_perm:[1,0,3,2] row_mask:0xf bank_mask:0xf
    v_fmac_f32_dpp v6, v170, v137 quad_perm:[1,0,3,2] row_mask:0xf bank_mask:0xf
    s_nop 0
    v_fmac_f32 v216, v36, v4
    v_fmac_f32 v232, v37, v5
    buffer_load_dwordx4 v[56:59], v117, s[44:47], s80 offen sc1
    v_fmac_f32 v248, v38, v6
    v_fmac_f32_dpp v216, v4, v148 quad_perm:[1,0,3,2] row_mask:0xf bank_mask:0xf
    v_fmac_f32_dpp v232, v5, v149 quad_perm:[1,0,3,2] row_mask:0xf bank_mask:0xf
    v_fmac_f32_dpp v248, v6, v150 quad_perm:[1,0,3,2] row_mask:0xf bank_mask:0xf
    v_fmac_f32 v217, v36, v216
    v_fmac_f32 v233, v37, v232
    v_fmac_f32 v249, v38, v248
    v_fmac_f32_dpp v217, v216, v148 quad_perm:[1,0,3,2] row_mask:0xf bank_mask:0xf
    v_fmac_f32_dpp v233, v232, v149 quad_perm:[1,0,3,2] row_mask:0xf bank_mask:0xf
    v_fmac_f32_dpp v249, v248, v150 quad_perm:[1,0,3,2] row_mask:0xf bank_mask:0xf
    buffer_load_dwordx4 v[60:63], v118, s[44:47], s80 offen sc1
    v_fmac_f32 v218, v36, v217
    v_fmac_f32 v234, v37, v233
    v_fmac_f32 v250, v38, v249
    v_fmac_f32_dpp v218, v217, v148 quad_perm:[1,0,3,2] row_mask:0xf bank_mask:0xf
    v_fmac_f32_dpp v234, v233, v149 quad_perm:[1,0,3,2] row_mask:0xf bank_mask:0xf
    v_fmac_f32_dpp v250, v249, v150 quad_perm:[1,0,3,2] row_mask:0xf bank_mask:0xf
    v_fmac_f32 v219, v36, v218
    v_fmac_f32 v235, v37, v234
    v_fmac_f32 v251, v38, v250
    v_fmac_f32_dpp v219, v218, v148 quad_perm:[1,0,3,2] row_mask:0xf bank_mask:0xf
    buffer_load_dwordx4 v[64:67], v119, s[44:47], s80 offen sc1
    s_add_u32 s80, s80, 1024
    v_fmac_f32_dpp v235, v234, v149 quad_perm:[1,0,3,2] row_mask:0xf bank_mask:0xf
    v_fmac_f32_dpp v251, v250, v150 quad_perm:[1,0,3,2] row_mask:0xf bank_mask:0xf
    v_fmac_f32 v220, v36, v219
    v_fmac_f32 v236, v37, v235
    v_fmac_f32 v252, v38, v251
    v_fmac_f32_dpp v220, v219, v148 quad_perm:[1,0,3,2] row_mask:0xf bank_mask:0xf
    v_fmac_f32_dpp v236, v235, v149 quad_perm:[1,0,3,2] row_mask:0xf bank_mask:0xf
    v_fmac_f32_dpp v252, v251, v150 quad_perm:[1,0,3,2] row_mask:0xf bank_mask:0xf
    v_fmac_f32 v221, v36, v220
    v_fmac_f32 v237, v37, v236
    buffer_load_dwordx4 v[68:71], v116, s[44:47], s80 offen sc1
    v_fmac_f32 v253, v38, v252
    v_fmac_f32_dpp v221, v220, v148 quad_perm:[1,0,3,2] row_mask:0xf bank_mask:0xf
    v_fmac_f32_dpp v237, v236, v149 quad_perm:[1,0,3,2] row_mask:0xf bank_mask:0xf
    v_fmac_f32_dpp v253, v252, v150 quad_perm:[1,0,3,2] row_mask:0xf bank_mask:0xf
    v_fmac_f32 v222, v36, v221
    v_fmac_f32 v238, v37, v237
    v_fmac_f32 v254, v38, v253
    v_fmac_f32_dpp v222, v221, v148 quad_perm:[1,0,3,2] row_mask:0xf bank_mask:0xf
    v_fmac_f32_dpp v238, v237, v149 quad_perm:[1,0,3,2] row_mask:0xf bank_mask:0xf
    buffer_load_dwordx4 v[72:75], v117, s[44:47], s80 offen sc1
    v_fmac_f32_dpp v254, v253, v150 quad_perm:[1,0,3,2] row_mask:0xf bank_mask:0xf
    v_fmac_f32 v223, v36, v222
    v_fmac_f32 v239, v37, v238
    v_fmac_f32 v255, v38, v254
    v_fmac_f32_dpp v223, v222, v148 quad_perm:[1,0,3,2] row_mask:0xf bank_mask:0xf
    v_fmac_f32_dpp v239, v238, v149 quad_perm:[1,0,3,2] row_mask:0xf bank_mask:0xf
    v_fmac_f32_dpp v255, v254, v150 quad_perm:[1,0,3,2] row_mask:0xf bank_mask:0xf
    v_fmac_f32 v224, v36, v223
    v_fmac_f32 v240, v37, v239
    v_fmac_f32_dpp v224, v223, v148 quad_perm:[1,0,3,2] row_mask:0xf bank_mask:0xf
    buffer_load_dwordx4 v[76:79], v118, s[44:47], s80 offen sc1
    v_fmac_f32_dpp v240, v239, v149 quad_perm:[1,0,3,2] row_mask:0xf bank_mask:0xf
    v_fmac_f32 v225, v36, v224
    v_fmac_f32 v241, v37, v240
    v_fmac_f32_dpp v225, v224, v148 quad_perm:[1,0,3,2] row_mask:0xf bank_mask:0xf
    v_fmac_f32_dpp v241, v240, v149 quad_perm:[1,0,3,2] row_mask:0xf bank_mask:0xf
    v_fmac_f32 v226, v36, v225
    v_fmac_f32 v242, v37, v241
    v_fmac_f32_dpp v226, v225, v148 quad_perm:[1,0,3,2] row_mask:0xf bank_mask:0xf
    v_fmac_f32_dpp v242, v241, v149 quad_perm:[1,0,3,2] row_mask:0xf bank_mask:0xf
    v_fmac_f32 v227, v36, v226
    buffer_load_dwordx4 v[80:83], v119, s[44:47], s80 offen sc1
    s_add_u32 s80, s80, 1024
    v_fmac_f32 v243, v37, v242
    v_fmac_f32_dpp v227, v226, v148 quad_perm:[1,0,3,2] row_mask:0xf bank_mask:0xf
    v_fmac_f32_dpp v243, v242, v149 quad_perm:[1,0,3,2] row_mask:0xf bank_mask:0xf
    v_fmac_f32 v228, v36, v227
    v_fmac_f32 v244, v37, v243
    v_fmac_f32_dpp v228, v227, v148 quad_perm:[1,0,3,2] row_mask:0xf bank_mask:0xf
    v_fmac_f32_dpp v244, v243, v149 quad_perm:[1,0,3,2] row_mask:0xf bank_mask:0xf
    v_fmac_f32 v229, v36, v228
    v_fmac_f32 v245, v37, v244
    v_fmac_f32_dpp v229, v228, v148 quad_perm:[1,0,3,2] row_mask:0xf bank_mask:0xf
    buffer_load_dwordx4 v[84:87], v116, s[44:47], s80 offen sc1
    v_fmac_f32_dpp v245, v244, v149 quad_perm:[1,0,3,2] row_mask:0xf bank_mask:0xf
    v_fmac_f32 v230, v36, v229
    v_fmac_f32 v246, v37, v245
    v_fmac_f32_dpp v230, v229, v148 quad_perm:[1,0,3,2] row_mask:0xf bank_mask:0xf
    v_fmac_f32_dpp v246, v245, v149 quad_perm:[1,0,3,2] row_mask:0xf bank_mask:0xf
    v_fmac_f32 v231, v36, v230
    v_fmac_f32 v247, v37, v246
    v_fmac_f32_dpp v231, v230, v148 quad_perm:[1,0,3,2] row_mask:0xf bank_mask:0xf
    v_fmac_f32_dpp v247, v246, v149 quad_perm:[1,0,3,2] row_mask:0xf bank_mask:0xf
    buffer_load_dwordx4 v[88:91], v117, s[44:47], s80 offen sc1
    v_cvt_pk_bf16_f32 v120, v216, v217
    v_cvt_pk_bf16_f32 v121, v218, v219
    v_cvt_pk_bf16_f32 v122, v220, v221
    v_cvt_pk_bf16_f32 v123, v222, v223
    v_cvt_pk_bf16_f32 v124, v224, v225
    v_cvt_pk_bf16_f32 v125, v226, v227
    v_cvt_pk_bf16_f32 v126, v228, v229
    v_cvt_pk_bf16_f32 v127, v230, v231
    v_cvt_pk_bf16_f32 v136, v232, v233
    v_cvt_pk_bf16_f32 v137, v234, v235
    buffer_load_dwordx4 v[92:95], v118, s[44:47], s80 offen sc1
    v_cvt_pk_bf16_f32 v138, v236, v237
    v_cvt_pk_bf16_f32 v139, v238, v239
    v_cvt_pk_bf16_f32 v140, v240, v241
    v_cvt_pk_bf16_f32 v141, v242, v243
    v_cvt_pk_bf16_f32 v142, v244, v245
    v_cvt_pk_bf16_f32 v143, v246, v247
    v_cvt_pk_bf16_f32 v152, v248, v249
    v_cvt_pk_bf16_f32 v153, v250, v251
    v_cvt_pk_bf16_f32 v154, v252, v253
    v_cvt_pk_bf16_f32 v155, v254, v255
    buffer_load_dwordx4 v[96:99], v119, s[44:47], s80 offen sc1
    s_add_u32 s80, s80, 1024
    v_and_b32 v19, 15, v1
    s_lshl_b32 s87, s70, 5
    v_add_u32 v20, s87, v19
    v_mul_u32_u24 v20, 272, v20
    v_lshl_add_u32 v20, v50, 5, v20
    v_add_u32 v19, 64, v19
    v_mul_u32_u24 v19, 272, v19
    v_lshl_add_u32 v19, v50, 5, v19
    s_lshl_b32 s87, s70, 4
    v_add_u32 v19, s87, v19
    ds_write_b128 v20, v[120:123]
    ds_write_b128 v20, v[124:127] offset:16
    ds_write_b128 v20, v[136:139] offset:4352
    ds_write_b128 v20, v[140:143] offset:4368
    ds_write_b128 v19, v[152:155]
    s_waitcnt lgkmcnt(0)
    s_barrier
    ds_read_b64_tr_b16 v[200:201], v2 offset:0
    ds_read_b64_tr_b16 v[202:203], v2 offset:2176
    ds_read_b64_tr_b16 v[204:205], v2 offset:4352
    ds_read_b64_tr_b16 v[206:207], v2 offset:6528
    ds_read_b64_tr_b16 v[208:209], v2 offset:8704
    ds_read_b64_tr_b16 v[210:211], v2 offset:10880
    ds_read_b64_tr_b16 v[212:213], v2 offset:13056
    ds_read_b64_tr_b16 v[214:215], v2 offset:15232
    ds_read_b64_tr_b16 v[216:217], v2 offset:17408
    ds_read_b64_tr_b16 v[218:219], v2 offset:19584
    s_waitcnt lgkmcnt(8)
    buffer_store_dwordx4 v[200:203], v3, s[44:47], s73 offen sc1
    s_waitcnt lgkmcnt(6)
    buffer_store_dwordx4 v[204:207], v3, s[44:47], s74 offen sc1
    s_waitcnt lgkmcnt(4)
    buffer_store_dwordx4 v[208:211], v3, s[44:47], s75 offen sc1
    s_waitcnt lgkmcnt(2)
    buffer_store_dwordx4 v[212:215], v3, s[44:47], s76 offen sc1
    s_waitcnt lgkmcnt(0)
    buffer_store_dwordx4 v[216:219], v3, s[44:47], s77 offen sc1
    s_mul_i32 s85, s92, 88
    s_mul_i32 s87, s68, 5
    s_add_u32 s85, s85, s87
    s_mul_i32 s85, s85, 5120
    s_add_u32 s86, s85, 4096
    s_waitcnt vmcnt(21)
    v_mfma_f32_16x16x32_bf16 v[120:123], a[104:107], a[88:91], 0
    v_mfma_f32_16x16x32_bf16 v[124:127], a[104:107], a[92:95], 0
    v_mfma_f32_16x16x32_bf16 v[128:131], a[104:107], a[96:99], 0
    v_mfma_f32_16x16x32_bf16 v[132:135], a[104:107], a[100:103], 0
    v_mfma_f32_16x16x32_bf16 v[136:139], a[108:111], a[88:91], 0
    v_mfma_f32_16x16x32_bf16 v[140:143], a[108:111], a[92:95], 0
    v_mfma_f32_16x16x32_bf16 v[144:147], a[108:111], a[96:99], 0
    v_mfma_f32_16x16x32_bf16 v[148:151], a[108:111], a[100:103], 0
    v_mfma_f32_16x16x32_bf16 v[152:155], a[112:115], a[88:91], 0
    v_mfma_f32_16x16x32_bf16 v[156:159], a[112:115], a[92:95], 0
    v_mfma_f32_16x16x32_bf16 v[160:163], a[112:115], a[96:99], 0
    v_mfma_f32_16x16x32_bf16 v[164:167], a[112:115], a[100:103], 0
    v_mfma_f32_16x16x32_bf16 v[168:171], a[116:119], a[88:91], 0
    v_mfma_f32_16x16x32_bf16 v[172:175], a[116:119], a[92:95], 0
    v_mfma_f32_16x16x32_bf16 v[176:179], a[116:119], a[96:99], 0
    v_mfma_f32_16x16x32_bf16 v[180:183], a[116:119], a[100:103], 0
    v_mfma_f32_16x16x32_bf16 v[184:187], a[120:123], a[88:91], 0
    v_mfma_f32_16x16x32_bf16 v[188:191], a[120:123], a[92:95], 0
    v_mfma_f32_16x16x32_bf16 v[192:195], a[120:123], a[96:99], 0
    v_mfma_f32_16x16x32_bf16 v[196:199], a[120:123], a[100:103], 0
    buffer_load_dwordx4 a[104:107], v51, s[40:43], s85 offen sc1
    buffer_load_dwordx4 a[108:111], v51, s[40:43], s85 offen offset:1024 sc1
    buffer_load_dwordx4 a[112:115], v51, s[40:43], s85 offen offset:2048 sc1
    buffer_load_dwordx4 a[88:91], v116, s[44:47], s80 offen sc1
    buffer_load_dwordx4 a[92:95], v117, s[44:47], s80 offen sc1
    buffer_load_dwordx4 a[96:99], v118, s[44:47], s80 offen sc1
    buffer_load_dwordx4 a[100:103], v119, s[44:47], s80 offen sc1
    s_add_u32 s80, s80, 1024
    s_waitcnt vmcnt(24)
    v_mfma_f32_16x16x32_bf16 v[120:123], a[124:127], v[100:103], v[120:123]
    v_mfma_f32_16x16x32_bf16 v[124:127], a[124:127], v[104:107], v[124:127]
    buffer_load_dwordx4 a[116:119], v51, s[40:43], s85 offen offset:3072 sc1
    v_mfma_f32_16x16x32_bf16 v[128:131], a[124:127], v[108:111], v[128:131]
    v_mfma_f32_16x16x32_bf16 v[132:135], a[124:127], v[112:115], v[132:135]
    v_mfma_f32_16x16x32_bf16 v[136:139], a[128:131], v[100:103], v[136:139]
    v_mfma_f32_16x16x32_bf16 v[140:143], a[128:131], v[104:107], v[140:143]
    buffer_load_dwordx4 a[120:123], v51, s[40:43], s86 offen sc1
    s_add_u32 s85, s85, 5120
    s_add_u32 s86, s86, 5120
    v_mfma_f32_16x16x32_bf16 v[144:147], a[128:131], v[108:111], v[144:147]
    v_mfma_f32_16x16x32_bf16 v[148:151], a[128:131], v[112:115], v[148:151]
    v_mfma_f32_16x16x32_bf16 v[152:155], a[132:135], v[100:103], v[152:155]
    v_mfma_f32_16x16x32_bf16 v[156:159], a[132:135], v[104:107], v[156:159]
    v_mfma_f32_16x16x32_bf16 v[160:163], a[132:135], v[108:111], v[160:163]
    v_mfma_f32_16x16x32_bf16 v[164:167], a[132:135], v[112:115], v[164:167]
    v_mfma_f32_16x16x32_bf16 v[168:171], a[136:139], v[100:103], v[168:171]
    v_mfma_f32_16x16x32_bf16 v[172:175], a[136:139], v[104:107], v[172:175]
    v_mfma_f32_16x16x32_bf16 v[176:179], a[136:139], v[108:111], v[176:179]
    v_mfma_f32_16x16x32_bf16 v[180:183], a[136:139], v[112:115], v[180:183]
    v_mfma_f32_16x16x32_bf16 v[184:187], a[140:143], v[100:103], v[184:187]
    v_mfma_f32_16x16x32_bf16 v[188:191], a[140:143], v[104:107], v[188:191]
    v_mfma_f32_16x16x32_bf16 v[192:195], a[140:143], v[108:111], v[192:195]
    v_mfma_f32_16x16x32_bf16 v[196:199], a[140:143], v[112:115], v[196:199]
    buffer_load_dwordx4 a[124:127], v51, s[40:43], s85 offen sc1
    buffer_load_dwordx4 v[100:103], v116, s[44:47], s80 offen sc1
    buffer_load_dwordx4 v[104:107], v117, s[44:47], s80 offen sc1
    buffer_load_dwordx4 v[108:111], v118, s[44:47], s80 offen sc1
    buffer_load_dwordx4 v[112:115], v119, s[44:47], s80 offen sc1
    s_add_u32 s80, s80, 1024
    s_waitcnt vmcnt(27)
    v_mfma_f32_16x16x32_bf16 v[120:123], a[144:147], v[52:55], v[120:123]
    v_mfma_f32_16x16x32_bf16 v[124:127], a[144:147], v[56:59], v[124:127]
    buffer_load_dwordx4 a[128:131], v51, s[40:43], s85 offen offset:1024 sc1
    v_mfma_f32_16x16x32_bf16 v[128:131], a[144:147], v[60:63], v[128:131]
    v_mfma_f32_16x16x32_bf16 v[132:135], a[144:147], v[64:67], v[132:135]
    v_mfma_f32_16x16x32_bf16 v[136:139], a[148:151], v[52:55], v[136:139]
    v_mfma_f32_16x16x32_bf16 v[140:143], a[148:151], v[56:59], v[140:143]
    buffer_load_dwordx4 a[132:135], v51, s[40:43], s85 offen offset:2048 sc1
    v_mfma_f32_16x16x32_bf16 v[144:147], a[148:151], v[60:63], v[144:147]
    v_mfma_f32_16x16x32_bf16 v[148:151], a[148:151], v[64:67], v[148:151]
    v_mfma_f32_16x16x32_bf16 v[152:155], a[152:155], v[52:55], v[152:155]
    v_mfma_f32_16x16x32_bf16 v[156:159], a[152:155], v[56:59], v[156:159]
    buffer_load_dwordx4 a[136:139], v51, s[40:43], s85 offen offset:3072 sc1
    v_mfma_f32_16x16x32_bf16 v[160:163], a[152:155], v[60:63], v[160:163]
    v_mfma_f32_16x16x32_bf16 v[164:167], a[152:155], v[64:67], v[164:167]
    v_mfma_f32_16x16x32_bf16 v[168:171], a[156:159], v[52:55], v[168:171]
    v_mfma_f32_16x16x32_bf16 v[172:175], a[156:159], v[56:59], v[172:175]
    v_mfma_f32_16x16x32_bf16 v[176:179], a[156:159], v[60:63], v[176:179]
    v_mfma_f32_16x16x32_bf16 v[180:183], a[156:159], v[64:67], v[180:183]
    v_mfma_f32_16x16x32_bf16 v[184:187], a[160:163], v[52:55], v[184:187]
    v_mfma_f32_16x16x32_bf16 v[188:191], a[160:163], v[56:59], v[188:191]
    v_mfma_f32_16x16x32_bf16 v[192:195], a[160:163], v[60:63], v[192:195]
    v_mfma_f32_16x16x32_bf16 v[196:199], a[160:163], v[64:67], v[196:199]
    buffer_load_dwordx4 v[52:55], v116, s[44:47], s80 offen sc1
    buffer_load_dwordx4 v[56:59], v117, s[44:47], s80 offen sc1
    buffer_load_dwordx4 v[60:63], v118, s[44:47], s80 offen sc1
    buffer_load_dwordx4 v[64:67], v119, s[44:47], s80 offen sc1
    s_add_u32 s80, s80, 1024
    s_waitcnt vmcnt(30)
    s_waitcnt vmcnt(21)
    v_add_u32 v19, 8192, v18
    v_mov_b32 v20, s3
    s_mov_b64 exec, 1
    global_store_dword v19, v20, s[36:37] sc1
    s_mov_b64 exec, -1
    v_mfma_f32_16x16x32_bf16 v[120:123], a[164:167], v[68:71], v[120:123]
    v_mfma_f32_16x16x32_bf16 v[124:127], a[164:167], v[72:75], v[124:127]
    buffer_load_dwordx4 a[140:143], v51, s[40:43], s86 offen sc1
    s_add_u32 s85, s85, 5120
    s_add_u32 s86, s86, 5120
    v_mfma_f32_16x16x32_bf16 v[128:131], a[164:167], v[76:79], v[128:131]
    v_mfma_f32_16x16x32_bf16 v[132:135], a[164:167], v[80:83], v[132:135]
    v_mfma_f32_16x16x32_bf16 v[136:139], a[168:171], v[68:71], v[136:139]
    v_mfma_f32_16x16x32_bf16 v[140:143], a[168:171], v[72:75], v[140:143]
    buffer_load_dwordx4 a[144:147], v51, s[40:43], s85 offen sc1
    v_mfma_f32_16x16x32_bf16 v[144:147], a[168:171], v[76:79], v[144:147]
    v_mfma_f32_16x16x32_bf16 v[148:151], a[168:171], v[80:83], v[148:151]
    v_mfma_f32_16x16x32_bf16 v[152:155], a[172:175], v[68:71], v[152:155]
    v_mfma_f32_16x16x32_bf16 v[156:159], a[172:175], v[72:75], v[156:159]
    buffer_load_dwordx4 a[148:151], v51, s[40:43], s85 offen offset:1024 sc1
    v_mfma_f32_16x16x32_bf16 v[160:163], a[172:175], v[76:79], v[160:163]
    v_mfma_f32_16x16x32_bf16 v[164:167], a[172:175], v[80:83], v[164:167]
    v_mfma_f32_16x16x32_bf16 v[168:171], a[176:179], v[68:71], v[168:171]
    v_mfma_f32_16x16x32_bf16 v[172:175], a[176:179], v[72:75], v[172:175]
    v_mfma_f32_16x16x32_bf16 v[176:179], a[176:179], v[76:79], v[176:179]
    v_mfma_f32_16x16x32_bf16 v[180:183], a[176:179], v[80:83], v[180:183]
    v_mfma_f32_16x16x32_bf16 v[184:187], a[180:183], v[68:71], v[184:187]
    v_mfma_f32_16x16x32_bf16 v[188:191], a[180:183], v[72:75], v[188:191]
    v_mfma_f32_16x16x32_bf16 v[192:195], a[180:183], v[76:79], v[192:195]
    v_mfma_f32_16x16x32_bf16 v[196:199], a[180:183], v[80:83], v[196:199]
    buffer_load_dwordx4 v[68:71], v116, s[44:47], s80 offen sc1
    buffer_load_dwordx4 v[72:75], v117, s[44:47], s80 offen sc1
    buffer_load_dwordx4 v[76:79], v118, s[44:47], s80 offen sc1
    buffer_load_dwordx4 v[80:83], v119, s[44:47], s80 offen sc1
    s_add_u32 s80, s80, 1024
    v_mfma_f32_16x16x32_bf16 v[120:123], a[184:187], v[84:87], v[120:123]
    v_mfma_f32_16x16x32_bf16 v[124:127], a[184:187], v[88:91], v[124:127]
    buffer_load_dwordx4 a[152:155], v51, s[40:43], s85 offen offset:2048 sc1
    v_mfma_f32_16x16x32_bf16 v[128:131], a[184:187], v[92:95], v[128:131]
    v_mfma_f32_16x16x32_bf16 v[132:135], a[184:187], v[96:99], v[132:135]
    v_mfma_f32_16x16x32_bf16 v[136:139], a[188:191], v[84:87], v[136:139]
    v_mfma_f32_16x16x32_bf16 v[140:143], a[188:191], v[88:91], v[140:143]
    buffer_load_dwordx4 a[156:159], v51, s[40:43], s85 offen offset:3072 sc1
    v_mfma_f32_16x16x32_bf16 v[144:147], a[188:191], v[92:95], v[144:147]
    v_mfma_f32_16x16x32_bf16 v[148:151], a[188:191], v[96:99], v[148:151]
    v_mfma_f32_16x16x32_bf16 v[152:155], a[192:195], v[84:87], v[152:155]
    v_mfma_f32_16x16x32_bf16 v[156:159], a[192:195], v[88:91], v[156:159]
    buffer_load_dwordx4 a[160:163], v51, s[40:43], s86 offen sc1
    s_add_u32 s85, s85, 5120
    s_add_u32 s86, s86, 5120
    v_mfma_f32_16x16x32_bf16 v[160:163], a[192:195], v[92:95], v[160:163]
    v_mfma_f32_16x16x32_bf16 v[164:167], a[192:195], v[96:99], v[164:167]
    v_mfma_f32_16x16x32_bf16 v[168:171], a[196:199], v[84:87], v[168:171]
    v_mfma_f32_16x16x32_bf16 v[172:175], a[196:199], v[88:91], v[172:175]
    v_mfma_f32_16x16x32_bf16 v[176:179], a[196:199], v[92:95], v[176:179]
    v_mfma_f32_16x16x32_bf16 v[180:183], a[196:199], v[96:99], v[180:183]
    v_mfma_f32_16x16x32_bf16 v[184:187], a[200:203], v[84:87], v[184:187]
    v_mfma_f32_16x16x32_bf16 v[188:191], a[200:203], v[88:91], v[188:191]
    v_mfma_f32_16x16x32_bf16 v[192:195], a[200:203], v[92:95], v[192:195]
    v_mfma_f32_16x16x32_bf16 v[196:199], a[200:203], v[96:99], v[196:199]
    buffer_load_dwordx4 v[84:87], v116, s[44:47], s80 offen sc1
    buffer_load_dwordx4 v[88:91], v117, s[44:47], s80 offen sc1
    buffer_load_dwordx4 v[92:95], v118, s[44:47], s80 offen sc1
    buffer_load_dwordx4 v[96:99], v119, s[44:47], s80 offen sc1
    s_add_u32 s80, s80, 1024
    s_waitcnt vmcnt(29)
    v_mfma_f32_16x16x32_bf16 v[120:123], a[204:207], a[88:91], v[120:123]
    v_mfma_f32_16x16x32_bf16 v[124:127], a[204:207], a[92:95], v[124:127]
    buffer_load_dwordx4 a[164:167], v51, s[40:43], s85 offen sc1
    v_mfma_f32_16x16x32_bf16 v[128:131], a[204:207], a[96:99], v[128:131]
    v_mfma_f32_16x16x32_bf16 v[132:135], a[204:207], a[100:103], v[132:135]
    v_mfma_f32_16x16x32_bf16 v[136:139], a[208:211], a[88:91], v[136:139]
    v_mfma_f32_16x16x32_bf16 v[140:143], a[208:211], a[92:95], v[140:143]
    buffer_load_dwordx4 a[168:171], v51, s[40:43], s85 offen offset:1024 sc1
    v_mfma_f32_16x16x32_bf16 v[144:147], a[208:211], a[96:99], v[144:147]
    v_mfma_f32_16x16x32_bf16 v[148:151], a[208:211], a[100:103], v[148:151]
    v_mfma_f32_16x16x32_bf16 v[152:155], a[212:215], a[88:91], v[152:155]
    v_mfma_f32_16x16x32_bf16 v[156:159], a[212:215], a[92:95], v[156:159]
    buffer_load_dwordx4 a[172:175], v51, s[40:43], s85 offen offset:2048 sc1
    v_mfma_f32_16x16x32_bf16 v[160:163], a[212:215], a[96:99], v[160:163]
    v_mfma_f32_16x16x32_bf16 v[164:167], a[212:215], a[100:103], v[164:167]
    v_mfma_f32_16x16x32_bf16 v[168:171], a[216:219], a[88:91], v[168:171]
    v_mfma_f32_16x16x32_bf16 v[172:175], a[216:219], a[92:95], v[172:175]
    v_mfma_f32_16x16x32_bf16 v[176:179], a[216:219], a[96:99], v[176:179]
    v_mfma_f32_16x16x32_bf16 v[180:183], a[216:219], a[100:103], v[180:183]
    v_mfma_f32_16x16x32_bf16 v[184:187], a[220:223], a[88:91], v[184:187]
    v_mfma_f32_16x16x32_bf16 v[188:191], a[220:223], a[92:95], v[188:191]
    v_mfma_f32_16x16x32_bf16 v[192:195], a[220:223], a[96:99], v[192:195]
    v_mfma_f32_16x16x32_bf16 v[196:199], a[220:223], a[100:103], v[196:199]
    buffer_load_dwordx4 a[88:91], v116, s[44:47], s80 offen sc1
    buffer_load_dwordx4 a[92:95], v117, s[44:47], s80 offen sc1
    buffer_load_dwordx4 a[96:99], v118, s[44:47], s80 offen sc1
    buffer_load_dwordx4 a[100:103], v119, s[44:47], s80 offen sc1
    s_add_u32 s80, s80, 1024
    s_waitcnt vmcnt(29)
    v_add_u32 v24, 8192, v24
    global_load_dword v21, v24, s[36:37] sc1
    v_mfma_f32_16x16x32_bf16 v[120:123], a[224:227], v[100:103], v[120:123]
    v_add_u32 v19, 0, v0
    v_mfma_f32_16x16x32_bf16 v[124:127], a[224:227], v[104:107], v[124:127]
    buffer_load_dwordx4 a[176:179], v51, s[40:43], s85 offen offset:3072 sc1
    v_mfma_f32_16x16x32_bf16 v[128:131], a[224:227], v[108:111], v[128:131]
    v_mul_u32_u24 v20, 3277, v19
    v_mfma_f32_16x16x32_bf16 v[132:135], a[224:227], v[112:115], v[132:135]
    v_lshrrev_b32 v20, 16, v20
    v_mfma_f32_16x16x32_bf16 v[136:139], a[228:231], v[100:103], v[136:139]
    v_mul_u32_u24 v22, 20, v20
    v_mfma_f32_16x16x32_bf16 v[140:143], a[228:231], v[104:107], v[140:143]
    buffer_load_dwordx4 a[180:183], v51, s[40:43], s86 offen sc1
    s_add_u32 s85, s85, 5120
    s_add_u32 s86, s86, 5120
    v_mfma_f32_16x16x32_bf16 v[144:147], a[228:231], v[108:111], v[144:147]
    v_sub_u32 v22, v19, v22
    v_mfma_f32_16x16x32_bf16 v[148:151], a[228:231], v[112:115], v[148:151]
    v_mul_u32_u24 v2, 336, v20
    v_mfma_f32_16x16x32_bf16 v[152:155], a[232:235], v[100:103], v[152:155]
    v_lshl_add_u32 v2, v22, 4, v2
    v_mfma_f32_16x16x32_bf16 v[156:159], a[232:235], v[104:107], v[156:159]
    buffer_load_dwordx4 a[184:187], v51, s[40:43], s85 offen sc1
    v_mfma_f32_16x16x32_bf16 v[160:163], a[232:235], v[108:111], v[160:163]
    v_lshrrev_b32 v19, 4, v20
    v_mfma_f32_16x16x32_bf16 v[164:167], a[232:235], v[112:115], v[164:167]
    v_lshl_add_u32 v2, v19, 6, v2
    v_mfma_f32_16x16x32_bf16 v[168:171], a[236:239], v[100:103], v[168:171]
    s_lshl_b32 s87, s91, 6
    v_mfma_f32_16x16x32_bf16 v[172:175], a[236:239], v[104:107], v[172:175]
    v_mfma_f32_16x16x32_bf16 v[176:179], a[236:239], v[108:111], v[176:179]
    v_add_u32 v20, s87, v20
    v_mfma_f32_16x16x32_bf16 v[180:183], a[236:239], v[112:115], v[180:183]
    v_mul_u32_u24 v20, 640, v20
    v_mfma_f32_16x16x32_bf16 v[184:187], a[240:243], v[100:103], v[184:187]
    s_mul_i32 s88, s92, 80
    v_mfma_f32_16x16x32_bf16 v[188:191], a[240:243], v[104:107], v[188:191]
    v_mfma_f32_16x16x32_bf16 v[192:195], a[240:243], v[108:111], v[192:195]
    v_lshl_add_u32 v22, v22, 2, s88
    v_mfma_f32_16x16x32_bf16 v[196:199], a[240:243], v[112:115], v[196:199]
    v_add_u32 v20, v20, v22
    buffer_load_dwordx4 v[100:103], v116, s[44:47], s80 offen sc1
    buffer_load_dwordx4 v[104:107], v117, s[44:47], s80 offen sc1
    buffer_load_dwordx4 v[108:111], v118, s[44:47], s80 offen sc1
    buffer_load_dwordx4 v[112:115], v119, s[44:47], s80 offen sc1
    s_add_u32 s80, s80, 1024
    s_waitcnt vmcnt(30)
    v_mfma_f32_16x16x32_bf16 v[120:123], a[0:3], v[52:55], v[120:123]
    v_lshlrev_b32 v7, 2, v20
    v_mfma_f32_16x16x32_bf16 v[124:127], a[0:3], v[56:59], v[124:127]
    buffer_load_dwordx4 a[188:191], v51, s[40:43], s85 offen offset:1024 sc1
    v_mfma_f32_16x16x32_bf16 v[128:131], a[0:3], v[60:63], v[128:131]
    v_add_u32 v19, 256, v0
    v_mfma_f32_16x16x32_bf16 v[132:135], a[0:3], v[64:67], v[132:135]
    v_mul_u32_u24 v20, 3277, v19
    v_mfma_f32_16x16x32_bf16 v[136:139], a[4:7], v[52:55], v[136:139]
    v_lshrrev_b32 v20, 16, v20
    v_mfma_f32_16x16x32_bf16 v[140:143], a[4:7], v[56:59], v[140:143]
    buffer_load_dwordx4 a[192:195], v51, s[40:43], s85 offen offset:2048 sc1
    v_mfma_f32_16x16x32_bf16 v[144:147], a[4:7], v[60:63], v[144:147]
    v_mul_u32_u24 v22, 20, v20
    v_mfma_f32_16x16x32_bf16 v[148:151], a[4:7], v[64:67], v[148:151]
    v_sub_u32 v22, v19, v22
    v_mfma_f32_16x16x32_bf16 v[152:155], a[8:11], v[52:55], v[152:155]
    v_mul_u32_u24 v3, 336, v20
    v_mfma_f32_16x16x32_bf16 v[156:159], a[8:11], v[56:59], v[156:159]
    buffer_load_dwordx4 a[196:199], v51, s[40:43], s85 offen offset:3072 sc1
    v_mfma_f32_16x16x32_bf16 v[160:163], a[8:11], v[60:63], v[160:163]
    v_lshl_add_u32 v3, v22, 4, v3
    v_mfma_f32_16x16x32_bf16 v[164:167], a[8:11], v[64:67], v[164:167]
    v_lshrrev_b32 v19, 4, v20
    v_mfma_f32_16x16x32_bf16 v[168:171], a[12:15], v[52:55], v[168:171]
    v_lshl_add_u32 v3, v19, 6, v3
    v_mfma_f32_16x16x32_bf16 v[172:175], a[12:15], v[56:59], v[172:175]
    v_mfma_f32_16x16x32_bf16 v[176:179], a[12:15], v[60:63], v[176:179]
    s_lshl_b32 s87, s91, 6
    v_mfma_f32_16x16x32_bf16 v[180:183], a[12:15], v[64:67], v[180:183]
    v_add_u32 v20, s87, v20
    v_mfma_f32_16x16x32_bf16 v[184:187], a[16:19], v[52:55], v[184:187]
    v_mul_u32_u24 v20, 640, v20
    v_mfma_f32_16x16x32_bf16 v[188:191], a[16:19], v[56:59], v[188:191]
    v_mfma_f32_16x16x32_bf16 v[192:195], a[16:19], v[60:63], v[192:195]
    s_mul_i32 s88, s92, 80
    v_mfma_f32_16x16x32_bf16 v[196:199], a[16:19], v[64:67], v[196:199]
    v_lshl_add_u32 v22, v22, 2, s88
    s_waitcnt vmcnt(25)
    s_waitcnt vmcnt(10)
    s_mov_b32 s95, 0
L_fachk:
    v_cmp_ne_u32 vcc, s3, v21
    s_nop 4
    s_cbranch_vccz L_faok
    s_add_u32 s95, s95, 1
    s_cmp_gt_u32 s95, 100000
    s_cbranch_scc1 L_faok
    global_load_dword v21, v24, s[36:37] sc1
    s_waitcnt vmcnt(0)
    s_branch L_fachk
L_faok:
    s_mul_i32 s80, s68, 5120
    v_mfma_f32_16x16x32_bf16 v[120:123], a[20:23], v[68:71], v[120:123]
    v_add_u32 v20, v20, v22
    v_mfma_f32_16x16x32_bf16 v[124:127], a[20:23], v[72:75], v[124:127]
    buffer_load_dwordx4 a[200:203], v51, s[40:43], s86 offen sc1
    s_add_u32 s85, s85, 81920
    s_add_u32 s86, s86, 81920
    v_mfma_f32_16x16x32_bf16 v[128:131], a[20:23], v[76:79], v[128:131]
    v_lshlrev_b32 v8, 2, v20
    v_mfma_f32_16x16x32_bf16 v[132:135], a[20:23], v[80:83], v[132:135]
    buffer_load_dwordx4 v[52:55], v116, s[44:47], s80 offen sc1
    v_mfma_f32_16x16x32_bf16 v[136:139], a[24:27], v[68:71], v[136:139]
    v_add_u32 v19, 512, v0
    v_mfma_f32_16x16x32_bf16 v[140:143], a[24:27], v[72:75], v[140:143]
    buffer_load_dwordx4 a[204:207], v51, s[40:43], s85 offen sc1
    v_mfma_f32_16x16x32_bf16 v[144:147], a[24:27], v[76:79], v[144:147]
    v_mul_u32_u24 v20, 3277, v19
    v_mfma_f32_16x16x32_bf16 v[148:151], a[24:27], v[80:83], v[148:151]
    buffer_load_dwordx4 v[56:59], v117, s[44:47], s80 offen sc1
    v_mfma_f32_16x16x32_bf16 v[152:155], a[28:31], v[68:71], v[152:155]
    v_lshrrev_b32 v20, 16, v20
    v_mfma_f32_16x16x32_bf16 v[156:159], a[28:31], v[72:75], v[156:159]
    buffer_load_dwordx4 a[208:211], v51, s[40:43], s85 offen offset:1024 sc1
    v_mfma_f32_16x16x32_bf16 v[160:163], a[28:31], v[76:79], v[160:163]
    v_mul_u32_u24 v22, 20, v20
    v_mfma_f32_16x16x32_bf16 v[164:167], a[28:31], v[80:83], v[164:167]
    buffer_load_dwordx4 v[60:63], v118, s[44:47], s80 offen sc1
    v_mfma_f32_16x16x32_bf16 v[168:171], a[32:35], v[68:71], v[168:171]
    v_sub_u32 v22, v19, v22
    v_mfma_f32_16x16x32_bf16 v[172:175], a[32:35], v[72:75], v[172:175]
    v_mfma_f32_16x16x32_bf16 v[176:179], a[32:35], v[76:79], v[176:179]
    v_mul_u32_u24 v4, 336, v20
    v_mfma_f32_16x16x32_bf16 v[180:183], a[32:35], v[80:83], v[180:183]
    buffer_load_dwordx4 v[64:67], v119, s[44:47], s80 offen sc1
    s_add_u32 s80, s80, 1024
    v_mfma_f32_16x16x32_bf16 v[184:187], a[36:39], v[68:71], v[184:187]
    v_lshl_add_u32 v4, v22, 4, v4
    v_mfma_f32_16x16x32_bf16 v[188:191], a[36:39], v[72:75], v[188:191]
    v_mfma_f32_16x16x32_bf16 v[192:195], a[36:39], v[76:79], v[192:195]
    v_lshrrev_b32 v19, 4, v20
    v_mfma_f32_16x16x32_bf16 v[196:199], a[36:39], v[80:83], v[196:199]
    v_lshl_add_u32 v4, v19, 6, v4
    v_mfma_f32_16x16x32_bf16 v[120:123], a[40:43], v[84:87], v[120:123]
    s_lshl_b32 s87, s91, 6
    v_mfma_f32_16x16x32_bf16 v[124:127], a[40:43], v[88:91], v[124:127]
    buffer_load_dwordx4 a[212:215], v51, s[40:43], s85 offen offset:2048 sc1
    v_mfma_f32_16x16x32_bf16 v[128:131], a[40:43], v[92:95], v[128:131]
    v_add_u32 v20, s87, v20
    v_mfma_f32_16x16x32_bf16 v[132:135], a[40:43], v[96:99], v[132:135]
    buffer_load_dwordx4 v[68:71], v116, s[44:47], s80 offen sc1
    v_mfma_f32_16x16x32_bf16 v[136:139], a[44:47], v[84:87], v[136:139]
    v_mul_u32_u24 v20, 640, v20
    v_mfma_f32_16x16x32_bf16 v[140:143], a[44:47], v[88:91], v[140:143]
    buffer_load_dwordx4 a[216:219], v51, s[40:43], s85 offen offset:3072 sc1
    v_mfma_f32_16x16x32_bf16 v[144:147], a[44:47], v[92:95], v[144:147]
    s_mul_i32 s88, s92, 80
    v_mfma_f32_16x16x32_bf16 v[148:151], a[44:47], v[96:99], v[148:151]
    buffer_load_dwordx4 v[72:75], v117, s[44:47], s80 offen sc1
    v_mfma_f32_16x16x32_bf16 v[152:155], a[48:51], v[84:87], v[152:155]
    v_lshl_add_u32 v22, v22, 2, s88
    v_mfma_f32_16x16x32_bf16 v[156:159], a[48:51], v[88:91], v[156:159]
    buffer_load_dwordx4 a[220:223], v51, s[40:43], s86 offen sc1
    s_add_u32 s85, s85, 5120
    s_add_u32 s86, s86, 5120
    v_mfma_f32_16x16x32_bf16 v[160:163], a[48:51], v[92:95], v[160:163]
    v_add_u32 v20, v20, v22
    v_mfma_f32_16x16x32_bf16 v[164:167], a[48:51], v[96:99], v[164:167]
    buffer_load_dwordx4 v[76:79], v118, s[44:47], s80 offen sc1
    v_mfma_f32_16x16x32_bf16 v[168:171], a[52:55], v[84:87], v[168:171]
    v_lshlrev_b32 v9, 2, v20
    v_mfma_f32_16x16x32_bf16 v[172:175], a[52:55], v[88:91], v[172:175]
    v_mfma_f32_16x16x32_bf16 v[176:179], a[52:55], v[92:95], v[176:179]
    v_add_u32 v19, 768, v0
    v_mfma_f32_16x16x32_bf16 v[180:183], a[52:55], v[96:99], v[180:183]
    buffer_load_dwordx4 v[80:83], v119, s[44:47], s80 offen sc1
    s_add_u32 s80, s80, 1024
    v_mfma_f32_16x16x32_bf16 v[184:187], a[56:59], v[84:87], v[184:187]
    v_mul_u32_u24 v20, 3277, v19
    v_mfma_f32_16x16x32_bf16 v[188:191], a[56:59], v[88:91], v[188:191]
    v_mfma_f32_16x16x32_bf16 v[192:195], a[56:59], v[92:95], v[192:195]
    v_lshrrev_b32 v20, 16, v20
    v_mfma_f32_16x16x32_bf16 v[196:199], a[56:59], v[96:99], v[196:199]
    v_mul_u32_u24 v22, 20, v20
    v_mfma_f32_16x16x32_bf16 v[120:123], a[60:63], a[88:91], v[120:123]
    v_sub_u32 v22, v19, v22
    v_mfma_f32_16x16x32_bf16 v[124:127], a[60:63], a[92:95], v[124:127]
    buffer_load_dwordx4 a[224:227], v51, s[40:43], s85 offen sc1
    v_mfma_f32_16x16x32_bf16 v[128:131], a[60:63], a[96:99], v[128:131]
    v_mul_u32_u24 v5, 336, v20
    v_mfma_f32_16x16x32_bf16 v[132:135], a[60:63], a[100:103], v[132:135]
    buffer_load_dwordx4 v[84:87], v116, s[44:47], s80 offen sc1
    v_mfma_f32_16x16x32_bf16 v[136:139], a[64:67], a[88:91], v[136:139]
    v_lshl_add_u32 v5, v22, 4, v5
    v_mfma_f32_16x16x32_bf16 v[140:143], a[64:67], a[92:95], v[140:143]
    buffer_load_dwordx4 a[228:231], v51, s[40:43], s85 offen offset:1024 sc1
    v_mfma_f32_16x16x32_bf16 v[144:147], a[64:67], a[96:99], v[144:147]
    v_lshrrev_b32 v19, 4, v20
    v_mfma_f32_16x16x32_bf16 v[148:151], a[64:67], a[100:103], v[148:151]
    buffer_load_dwordx4 v[88:91], v117, s[44:47], s80 offen sc1
    v_mfma_f32_16x16x32_bf16 v[152:155], a[68:71], a[88:91], v[152:155]
    v_lshl_add_u32 v5, v19, 6, v5
    v_mfma_f32_16x16x32_bf16 v[156:159], a[68:71], a[92:95], v[156:159]
    buffer_load_dwordx4 a[232:235], v51, s[40:43], s85 offen offset:2048 sc1
    v_mfma_f32_16x16x32_bf16 v[160:163], a[68:71], a[96:99], v[160:163]
    s_lshl_b32 s87, s91, 6
    v_mfma_f32_16x16x32_bf16 v[164:167], a[68:71], a[100:103], v[164:167]
    buffer_load_dwordx4 v[92:95], v118, s[44:47], s80 offen sc1
    v_mfma_f32_16x16x32_bf16 v[168:171], a[72:75], a[88:91], v[168:171]
    v_add_u32 v20, s87, v20
    v_mfma_f32_16x16x32_bf16 v[172:175], a[72:75], a[92:95], v[172:175]
    v_mfma_f32_16x16x32_bf16 v[176:179], a[72:75], a[96:99], v[176:179]
    v_mul_u32_u24 v20, 640, v20
    v_mfma_f32_16x16x32_bf16 v[180:183], a[72:75], a[100:103], v[180:183]
    buffer_load_dwordx4 v[96:99], v119, s[44:47], s80 offen sc1
    s_add_u32 s80, s80, 1024
    v_mfma_f32_16x16x32_bf16 v[184:187], a[76:79], a[88:91], v[184:187]
    s_mul_i32 s88, s92, 80
    v_mfma_f32_16x16x32_bf16 v[188:191], a[76:79], a[92:95], v[188:191]
    v_mfma_f32_16x16x32_bf16 v[192:195], a[76:79], a[96:99], v[192:195]
    v_lshl_add_u32 v22, v22, 2, s88
    v_mfma_f32_16x16x32_bf16 v[196:199], a[76:79], a[100:103], v[196:199]
    v_add_u32 v20, v20, v22
    s_waitcnt vmcnt(24)
    v_mfma_f32_16x16x32_bf16 v[120:123], a[80:83], v[100:103], v[120:123]
    v_lshlrev_b32 v10, 2, v20
    v_mfma_f32_16x16x32_bf16 v[124:127], a[80:83], v[104:107], v[124:127]
    buffer_load_dwordx4 a[236:239], v51, s[40:43], s85 offen offset:3072 sc1
    v_mfma_f32_16x16x32_bf16 v[128:131], a[80:83], v[108:111], v[128:131]
    v_add_u32 v19, 1024, v0
    v_mfma_f32_16x16x32_bf16 v[132:135], a[80:83], v[112:115], v[132:135]
    buffer_load_dwordx4 a[88:91], v116, s[44:47], s80 offen sc1
    v_mfma_f32_16x16x32_bf16 v[136:139], a[84:87], v[100:103], v[136:139]
    v_mul_u32_u24 v20, 3277, v19
    v_mfma_f32_16x16x32_bf16 v[140:143], a[84:87], v[104:107], v[140:143]
    buffer_load_dwordx4 a[240:243], v51, s[40:43], s86 offen sc1
    s_add_u32 s85, s85, 5120
    s_add_u32 s86, s86, 5120
    v_mfma_f32_16x16x32_bf16 v[144:147], a[84:87], v[108:111], v[144:147]
    v_lshrrev_b32 v20, 16, v20
    v_mfma_f32_16x16x32_bf16 v[148:151], a[84:87], v[112:115], v[148:151]
    buffer_load_dwordx4 a[92:95], v117, s[44:47], s80 offen sc1
    v_mfma_f32_16x16x32_bf16 v[152:155], a[244:247], v[100:103], v[152:155]
    v_mul_u32_u24 v22, 20, v20
    v_mfma_f32_16x16x32_bf16 v[156:159], a[244:247], v[104:107], v[156:159]
    buffer_load_dwordx4 a[0:3], v51, s[40:43], s85 offen sc1
    v_mfma_f32_16x16x32_bf16 v[160:163], a[244:247], v[108:111], v[160:163]
    v_sub_u32 v22, v19, v22
    v_mfma_f32_16x16x32_bf16 v[164:167], a[244:247], v[112:115], v[164:167]
    buffer_load_dwordx4 a[96:99], v118, s[44:47], s80 offen sc1
    v_mfma_f32_16x16x32_bf16 v[168:171], a[248:251], v[100:103], v[168:171]
    v_mul_u32_u24 v6, 336, v20
    v_mfma_f32_16x16x32_bf16 v[172:175], a[248:251], v[104:107], v[172:175]
    v_mfma_f32_16x16x32_bf16 v[176:179], a[248:251], v[108:111], v[176:179]
    v_lshl_add_u32 v6, v22, 4, v6
    v_mfma_f32_16x16x32_bf16 v[180:183], a[248:251], v[112:115], v[180:183]
    buffer_load_dwordx4 a[100:103], v119, s[44:47], s80 offen sc1
    s_add_u32 s80, s80, 1024
    v_mfma_f32_16x16x32_bf16 v[184:187], a[252:255], v[100:103], v[184:187]
    v_lshrrev_b32 v19, 4, v20
    v_mfma_f32_16x16x32_bf16 v[188:191], a[252:255], v[104:107], v[188:191]
    v_mfma_f32_16x16x32_bf16 v[192:195], a[252:255], v[108:111], v[192:195]
    v_lshl_add_u32 v6, v19, 6, v6
    v_mfma_f32_16x16x32_bf16 v[196:199], a[252:255], v[112:115], v[196:199]
    s_lshl_b32 s87, s91, 6
    s_waitcnt vmcnt(21)
    v_mfma_f32_16x16x32_bf16 v[200:203], a[104:107], v[52:55], 0
    v_add_u32 v20, s87, v20
    v_mfma_f32_16x16x32_bf16 v[204:207], a[104:107], v[56:59], 0
    buffer_load_dwordx4 a[4:7], v51, s[40:43], s85 offen offset:1024 sc1
    v_mfma_f32_16x16x32_bf16 v[208:211], a[104:107], v[60:63], 0
    v_mul_u32_u24 v20, 640, v20
    v_mfma_f32_16x16x32_bf16 v[212:215], a[104:107], v[64:67], 0
    buffer_load_dwordx4 v[100:103], v116, s[44:47], s80 offen sc1
    v_mfma_f32_16x16x32_bf16 v[216:219], a[108:111], v[52:55], 0
    s_mul_i32 s88, s92, 80
    v_mfma_f32_16x16x32_bf16 v[220:223], a[108:111], v[56:59], 0
    buffer_load_dwordx4 a[8:11], v51, s[40:43], s85 offen offset:2048 sc1
    v_mfma_f32_16x16x32_bf16 v[224:227], a[108:111], v[60:63], 0
    v_lshl_add_u32 v22, v22, 2, s88
    v_mfma_f32_16x16x32_bf16 v[228:231], a[108:111], v[64:67], 0
    buffer_load_dwordx4 v[104:107], v117, s[44:47], s80 offen sc1
    v_mfma_f32_16x16x32_bf16 v[232:235], a[112:115], v[52:55], 0
    v_add_u32 v20, v20, v22
    v_mfma_f32_16x16x32_bf16 v[236:239], a[112:115], v[56:59], 0
    buffer_load_dwordx4 a[12:15], v51, s[40:43], s85 offen offset:3072 sc1
    v_mfma_f32_16x16x32_bf16 v[240:243], a[112:115], v[60:63], 0
    v_lshlrev_b32 v11, 2, v20
    v_mfma_f32_16x16x32_bf16 v[244:247], a[112:115], v[64:67], 0
    buffer_load_dwordx4 v[108:111], v118, s[44:47], s80 offen sc1
    v_mfma_f32_16x16x32_bf16 v[248:251], a[116:119], v[52:55], 0
    v_and_b32 v19, 15, v1
    v_mfma_f32_16x16x32_bf16 v[252:255], a[116:119], v[56:59], 0
    v_mfma_f32_16x16x32_bf16 v[26:29], a[116:119], v[60:63], 0
    v_lshrrev_b32 v20, 2, v19
    v_mfma_f32_16x16x32_bf16 v[30:33], a[116:119], v[64:67], 0
    buffer_load_dwordx4 v[112:115], v119, s[44:47], s80 offen sc1
    s_add_u32 s80, s80, 1024
    v_mfma_f32_16x16x32_bf16 v[34:37], a[120:123], v[52:55], 0
    v_lshlrev_b32 v20, 4, v20
    v_mfma_f32_16x16x32_bf16 v[38:41], a[120:123], v[56:59], 0
    v_mfma_f32_16x16x32_bf16 v[42:45], a[120:123], v[60:63], 0
    v_and_b32 v19, 3, v19
    v_mfma_f32_16x16x32_bf16 v[46:49], a[120:123], v[64:67], 0
    v_add_u32 v19, v19, v20
    s_waitcnt vmcnt(21)
    v_mfma_f32_16x16x32_bf16 v[200:203], a[124:127], v[68:71], v[200:203]
    s_lshl_b32 s87, s91, 6
    v_mfma_f32_16x16x32_bf16 v[204:207], a[124:127], v[72:75], v[204:207]
    buffer_load_dwordx4 a[16:19], v51, s[40:43], s86 offen sc1
    s_add_u32 s85, s85, 5120
    s_add_u32 s86, s86, 5120
    v_mfma_f32_16x16x32_bf16 v[208:211], a[124:127], v[76:79], v[208:211]
    v_add_u32 v20, s87, v19
    v_mfma_f32_16x16x32_bf16 v[212:215], a[124:127], v[80:83], v[212:215]
    v_lshlrev_b32 v20, 2, v20
    v_mfma_f32_16x16x32_bf16 v[216:219], a[128:131], v[68:71], v[216:219]
    v_add_u32 v50, 11534336, v20
    v_mfma_f32_16x16x32_bf16 v[220:223], a[128:131], v[72:75], v[220:223]
    buffer_load_dwordx4 a[20:23], v51, s[40:43], s85 offen sc1
    v_mfma_f32_16x16x32_bf16 v[224:227], a[128:131], v[76:79], v[224:227]
    v_lshrrev_b32 v22, 4, v19
    v_mfma_f32_16x16x32_bf16 v[228:231], a[128:131], v[80:83], v[228:231]
    v_mul_u32_u24 v19, 336, v19
    v_mfma_f32_16x16x32_bf16 v[232:235], a[132:135], v[68:71], v[232:235]
    v_lshl_add_u32 v19, v22, 6, v19
    v_mfma_f32_16x16x32_bf16 v[236:239], a[132:135], v[72:75], v[236:239]
    buffer_load_dwordx4 a[24:27], v51, s[40:43], s85 offen offset:1024 sc1
    v_mfma_f32_16x16x32_bf16 v[240:243], a[132:135], v[76:79], v[240:243]
    v_lshrrev_b32 v22, 4, v1
    v_mfma_f32_16x16x32_bf16 v[244:247], a[132:135], v[80:83], v[244:247]
    v_lshl_add_u32 v19, v22, 4, v19
    v_mfma_f32_16x16x32_bf16 v[248:251], a[136:139], v[68:71], v[248:251]
    s_mul_i32 s87, s68, 21760
    v_mfma_f32_16x16x32_bf16 v[252:255], a[136:139], v[72:75], v[252:255]
    v_mfma_f32_16x16x32_bf16 v[26:29], a[136:139], v[76:79], v[26:29]
    v_add_u32 v25, s87, v19
    v_mfma_f32_16x16x32_bf16 v[30:33], a[136:139], v[80:83], v[30:33]
    v_mfma_f32_16x16x32_bf16 v[34:37], a[140:143], v[68:71], v[34:37]
    v_mfma_f32_16x16x32_bf16 v[38:41], a[140:143], v[72:75], v[38:41]
    v_mfma_f32_16x16x32_bf16 v[42:45], a[140:143], v[76:79], v[42:45]
    v_mfma_f32_16x16x32_bf16 v[46:49], a[140:143], v[80:83], v[46:49]
    s_waitcnt vmcnt(17)
    s_add_u32 s80, s80, 15360
    v_mfma_f32_16x16x32_bf16 v[200:203], a[144:147], v[84:87], v[200:203]
    v_mfma_f32_16x16x32_bf16 v[204:207], a[144:147], v[88:91], v[204:207]
    buffer_load_dwordx4 a[28:31], v51, s[40:43], s85 offen offset:2048 sc1
    v_mfma_f32_16x16x32_bf16 v[208:211], a[144:147], v[92:95], v[208:211]
    v_mfma_f32_16x16x32_bf16 v[212:215], a[144:147], v[96:99], v[212:215]
    buffer_load_dwordx4 v[52:55], v116, s[44:47], s80 offen sc1
    v_mfma_f32_16x16x32_bf16 v[216:219], a[148:151], v[84:87], v[216:219]
    v_mfma_f32_16x16x32_bf16 v[220:223], a[148:151], v[88:91], v[220:223]
    buffer_load_dwordx4 a[32:35], v51, s[40:43], s85 offen offset:3072 sc1
    v_mfma_f32_16x16x32_bf16 v[224:227], a[148:151], v[92:95], v[224:227]
    v_mfma_f32_16x16x32_bf16 v[228:231], a[148:151], v[96:99], v[228:231]
    buffer_load_dwordx4 v[56:59], v117, s[44:47], s80 offen sc1
    v_mfma_f32_16x16x32_bf16 v[232:235], a[152:155], v[84:87], v[232:235]
    v_mfma_f32_16x16x32_bf16 v[236:239], a[152:155], v[88:91], v[236:239]
    buffer_load_dwordx4 a[36:39], v51, s[40:43], s86 offen sc1
    s_add_u32 s85, s85, 5120
    s_add_u32 s86, s86, 5120
    v_mfma_f32_16x16x32_bf16 v[240:243], a[152:155], v[92:95], v[240:243]
    v_mfma_f32_16x16x32_bf16 v[244:247], a[152:155], v[96:99], v[244:247]
    buffer_load_dwordx4 v[60:63], v118, s[44:47], s80 offen sc1
    v_mfma_f32_16x16x32_bf16 v[248:251], a[156:159], v[84:87], v[248:251]
    v_mfma_f32_16x16x32_bf16 v[252:255], a[156:159], v[88:91], v[252:255]
    v_mfma_f32_16x16x32_bf16 v[26:29], a[156:159], v[92:95], v[26:29]
    v_mfma_f32_16x16x32_bf16 v[30:33], a[156:159], v[96:99], v[30:33]
    buffer_load_dwordx4 v[64:67], v119, s[44:47], s80 offen sc1
    s_add_u32 s80, s80, 1024
    v_mfma_f32_16x16x32_bf16 v[34:37], a[160:163], v[84:87], v[34:37]
    v_mfma_f32_16x16x32_bf16 v[38:41], a[160:163], v[88:91], v[38:41]
    v_mfma_f32_16x16x32_bf16 v[42:45], a[160:163], v[92:95], v[42:45]
    v_mfma_f32_16x16x32_bf16 v[46:49], a[160:163], v[96:99], v[46:49]
    s_waitcnt vmcnt(17)
    s_barrier
    global_load_dword v12, v50, s[36:37] offset:0 sc1
    global_load_dword v14, v50, s[36:37] offset:16 sc1
    global_load_dword v16, v50, s[36:37] offset:32 sc1
    global_load_dword v22, v50, s[36:37] offset:48 sc1
    v_mfma_f32_16x16x32_bf16 v[200:203], a[164:167], a[88:91], v[200:203]
    v_mfma_f32_16x16x32_bf16 v[204:207], a[164:167], a[92:95], v[204:207]
    buffer_load_dwordx4 a[40:43], v51, s[40:43], s85 offen sc1
    v_mfma_f32_16x16x32_bf16 v[208:211], a[164:167], a[96:99], v[208:211]
    v_mfma_f32_16x16x32_bf16 v[212:215], a[164:167], a[100:103], v[212:215]
    buffer_load_dwordx4 v[68:71], v116, s[44:47], s80 offen sc1
    v_mfma_f32_16x16x32_bf16 v[216:219], a[168:171], a[88:91], v[216:219]
    v_mfma_f32_16x16x32_bf16 v[220:223], a[168:171], a[92:95], v[220:223]
    buffer_load_dwordx4 a[44:47], v51, s[40:43], s85 offen offset:1024 sc1
    v_mfma_f32_16x16x32_bf16 v[224:227], a[168:171], a[96:99], v[224:227]
    v_mfma_f32_16x16x32_bf16 v[228:231], a[168:171], a[100:103], v[228:231]
    buffer_load_dwordx4 v[72:75], v117, s[44:47], s80 offen sc1
    v_mfma_f32_16x16x32_bf16 v[232:235], a[172:175], a[88:91], v[232:235]
    v_mfma_f32_16x16x32_bf16 v[236:239], a[172:175], a[92:95], v[236:239]
    buffer_load_dwordx4 a[48:51], v51, s[40:43], s85 offen offset:2048 sc1
    v_mfma_f32_16x16x32_bf16 v[240:243], a[172:175], a[96:99], v[240:243]
    v_mfma_f32_16x16x32_bf16 v[244:247], a[172:175], a[100:103], v[244:247]
    buffer_load_dwordx4 v[76:79], v118, s[44:47], s80 offen sc1
    v_mfma_f32_16x16x32_bf16 v[248:251], a[176:179], a[88:91], v[248:251]
    v_mfma_f32_16x16x32_bf16 v[252:255], a[176:179], a[92:95], v[252:255]
    v_mfma_f32_16x16x32_bf16 v[26:29], a[176:179], a[96:99], v[26:29]
    v_mfma_f32_16x16x32_bf16 v[30:33], a[176:179], a[100:103], v[30:33]
    buffer_load_dwordx4 v[80:83], v119, s[44:47], s80 offen sc1
    s_add_u32 s80, s80, 1024
    v_mfma_f32_16x16x32_bf16 v[34:37], a[180:183], a[88:91], v[34:37]
    v_mfma_f32_16x16x32_bf16 v[38:41], a[180:183], a[92:95], v[38:41]
    v_mfma_f32_16x16x32_bf16 v[42:45], a[180:183], a[96:99], v[42:45]
    v_mfma_f32_16x16x32_bf16 v[46:49], a[180:183], a[100:103], v[46:49]
    s_waitcnt vmcnt(21)
    v_mfma_f32_16x16x32_bf16 v[200:203], a[184:187], v[100:103], v[200:203]
    v_mfma_f32_16x16x32_bf16 v[204:207], a[184:187], v[104:107], v[204:207]
    buffer_load_dwordx4 a[52:55], v51, s[40:43], s85 offen offset:3072 sc1
    v_mfma_f32_16x16x32_bf16 v[208:211], a[184:187], v[108:111], v[208:211]
    v_mfma_f32_16x16x32_bf16 v[212:215], a[184:187], v[112:115], v[212:215]
    buffer_load_dwordx4 v[84:87], v116, s[44:47], s80 offen sc1
    v_mfma_f32_16x16x32_bf16 v[216:219], a[188:191], v[100:103], v[216:219]
    v_mfma_f32_16x16x32_bf16 v[220:223], a[188:191], v[104:107], v[220:223]
    buffer_load_dwordx4 a[56:59], v51, s[40:43], s86 offen sc1
    s_add_u32 s85, s85, 5120
    s_add_u32 s86, s86, 5120
    v_mfma_f32_16x16x32_bf16 v[224:227], a[188:191], v[108:111], v[224:227]
    v_mfma_f32_16x16x32_bf16 v[228:231], a[188:191], v[112:115], v[228:231]
    buffer_load_dwordx4 v[88:91], v117, s[44:47], s80 offen sc1
    v_mfma_f32_16x16x32_bf16 v[232:235], a[192:195], v[100:103], v[232:235]
    v_mfma_f32_16x16x32_bf16 v[236:239], a[192:195], v[104:107], v[236:239]
    v_mfma_f32_16x16x32_bf16 v[240:243], a[192:195], v[108:111], v[240:243]
    v_mfma_f32_16x16x32_bf16 v[244:247], a[192:195], v[112:115], v[244:247]
    buffer_load_dwordx4 v[92:95], v118, s[44:47], s80 offen sc1
    v_mfma_f32_16x16x32_bf16 v[248:251], a[196:199], v[100:103], v[248:251]
    v_mfma_f32_16x16x32_bf16 v[252:255], a[196:199], v[104:107], v[252:255]
    v_mfma_f32_16x16x32_bf16 v[26:29], a[196:199], v[108:111], v[26:29]
    v_mfma_f32_16x16x32_bf16 v[30:33], a[196:199], v[112:115], v[30:33]
    buffer_load_dwordx4 v[96:99], v119, s[44:47], s80 offen sc1
    s_add_u32 s80, s80, 1024
    v_mfma_f32_16x16x32_bf16 v[34:37], a[200:203], v[100:103], v[34:37]
    v_mfma_f32_16x16x32_bf16 v[38:41], a[200:203], v[104:107], v[38:41]
    v_mfma_f32_16x16x32_bf16 v[42:45], a[200:203], v[108:111], v[42:45]
    v_mfma_f32_16x16x32_bf16 v[46:49], a[200:203], v[112:115], v[46:49]
    s_waitcnt vmcnt(17)
    v_mfma_f32_16x16x32_bf16 v[200:203], a[204:207], v[52:55], v[200:203]
    v_mfma_f32_16x16x32_bf16 v[204:207], a[204:207], v[56:59], v[204:207]
    v_mfma_f32_16x16x32_bf16 v[208:211], a[204:207], v[60:63], v[208:211]
    v_mfma_f32_16x16x32_bf16 v[212:215], a[204:207], v[64:67], v[212:215]
    buffer_load_dwordx4 a[88:91], v116, s[44:47], s80 offen sc1
    v_mfma_f32_16x16x32_bf16 v[216:219], a[208:211], v[52:55], v[216:219]
    v_mfma_f32_16x16x32_bf16 v[220:223], a[208:211], v[56:59], v[220:223]
    v_mfma_f32_16x16x32_bf16 v[224:227], a[208:211], v[60:63], v[224:227]
    v_mfma_f32_16x16x32_bf16 v[228:231], a[208:211], v[64:67], v[228:231]
    buffer_load_dwordx4 a[92:95], v117, s[44:47], s80 offen sc1
    v_mfma_f32_16x16x32_bf16 v[232:235], a[212:215], v[52:55], v[232:235]
    v_mfma_f32_16x16x32_bf16 v[236:239], a[212:215], v[56:59], v[236:239]
    v_mfma_f32_16x16x32_bf16 v[240:243], a[212:215], v[60:63], v[240:243]
    v_mfma_f32_16x16x32_bf16 v[244:247], a[212:215], v[64:67], v[244:247]
    buffer_load_dwordx4 a[96:99], v118, s[44:47], s80 offen sc1
    v_mfma_f32_16x16x32_bf16 v[248:251], a[216:219], v[52:55], v[248:251]
    v_mfma_f32_16x16x32_bf16 v[252:255], a[216:219], v[56:59], v[252:255]
    v_mfma_f32_16x16x32_bf16 v[26:29], a[216:219], v[60:63], v[26:29]
    v_mfma_f32_16x16x32_bf16 v[30:33], a[216:219], v[64:67], v[30:33]
    buffer_load_dwordx4 a[100:103], v119, s[44:47], s80 offen sc1
    s_add_u32 s80, s80, 1024
    v_mfma_f32_16x16x32_bf16 v[34:37], a[220:223], v[52:55], v[34:37]
    v_mfma_f32_16x16x32_bf16 v[38:41], a[220:223], v[56:59], v[38:41]
    v_mfma_f32_16x16x32_bf16 v[42:45], a[220:223], v[60:63], v[42:45]
    v_mfma_f32_16x16x32_bf16 v[46:49], a[220:223], v[64:67], v[46:49]
    s_waitcnt vmcnt(10)
    v_mfma_f32_16x16x32_bf16 v[200:203], a[224:227], v[68:71], v[200:203]
    v_mfma_f32_16x16x32_bf16 v[204:207], a[224:227], v[72:75], v[204:207]
    v_mfma_f32_16x16x32_bf16 v[208:211], a[224:227], v[76:79], v[208:211]
    v_mfma_f32_16x16x32_bf16 v[212:215], a[224:227], v[80:83], v[212:215]
    buffer_load_dwordx4 v[100:103], v116, s[44:47], s80 offen sc1
    v_mfma_f32_16x16x32_bf16 v[216:219], a[228:231], v[68:71], v[216:219]
    v_mfma_f32_16x16x32_bf16 v[220:223], a[228:231], v[72:75], v[220:223]
    v_mfma_f32_16x16x32_bf16 v[224:227], a[228:231], v[76:79], v[224:227]
    v_mfma_f32_16x16x32_bf16 v[228:231], a[228:231], v[80:83], v[228:231]
    buffer_load_dwordx4 v[104:107], v117, s[44:47], s80 offen sc1
    v_mfma_f32_16x16x32_bf16 v[232:235], a[232:235], v[68:71], v[232:235]
    v_mfma_f32_16x16x32_bf16 v[236:239], a[232:235], v[72:75], v[236:239]
    v_mfma_f32_16x16x32_bf16 v[240:243], a[232:235], v[76:79], v[240:243]
    v_mfma_f32_16x16x32_bf16 v[244:247], a[232:235], v[80:83], v[244:247]
    buffer_load_dwordx4 v[108:111], v118, s[44:47], s80 offen sc1
    v_mfma_f32_16x16x32_bf16 v[248:251], a[236:239], v[68:71], v[248:251]
    v_mfma_f32_16x16x32_bf16 v[252:255], a[236:239], v[72:75], v[252:255]
    v_mfma_f32_16x16x32_bf16 v[26:29], a[236:239], v[76:79], v[26:29]
    v_mfma_f32_16x16x32_bf16 v[30:33], a[236:239], v[80:83], v[30:33]
    buffer_load_dwordx4 v[112:115], v119, s[44:47], s80 offen sc1
    s_add_u32 s80, s80, 1024
    v_mfma_f32_16x16x32_bf16 v[34:37], a[240:243], v[68:71], v[34:37]
    v_mfma_f32_16x16x32_bf16 v[38:41], a[240:243], v[72:75], v[38:41]
    v_mfma_f32_16x16x32_bf16 v[42:45], a[240:243], v[76:79], v[42:45]
    v_mfma_f32_16x16x32_bf16 v[46:49], a[240:243], v[80:83], v[46:49]
    s_waitcnt vmcnt(8)
    v_mfma_f32_16x16x32_bf16 v[200:203], a[0:3], v[84:87], v[200:203]
    v_mfma_f32_16x16x32_bf16 v[204:207], a[0:3], v[88:91], v[204:207]
    v_mfma_f32_16x16x32_bf16 v[208:211], a[0:3], v[92:95], v[208:211]
    v_mfma_f32_16x16x32_bf16 v[212:215], a[0:3], v[96:99], v[212:215]
    v_mfma_f32_16x16x32_bf16 v[216:219], a[4:7], v[84:87], v[216:219]
    v_mfma_f32_16x16x32_bf16 v[220:223], a[4:7], v[88:91], v[220:223]
    v_mfma_f32_16x16x32_bf16 v[224:227], a[4:7], v[92:95], v[224:227]
    v_mfma_f32_16x16x32_bf16 v[228:231], a[4:7], v[96:99], v[228:231]
    v_mfma_f32_16x16x32_bf16 v[232:235], a[8:11], v[84:87], v[232:235]
    v_mfma_f32_16x16x32_bf16 v[236:239], a[8:11], v[88:91], v[236:239]
    v_mfma_f32_16x16x32_bf16 v[240:243], a[8:11], v[92:95], v[240:243]
    v_mfma_f32_16x16x32_bf16 v[244:247], a[8:11], v[96:99], v[244:247]
    v_mfma_f32_16x16x32_bf16 v[248:251], a[12:15], v[84:87], v[248:251]
    v_mfma_f32_16x16x32_bf16 v[252:255], a[12:15], v[88:91], v[252:255]
    v_mfma_f32_16x16x32_bf16 v[26:29], a[12:15], v[92:95], v[26:29]
    v_mfma_f32_16x16x32_bf16 v[30:33], a[12:15], v[96:99], v[30:33]
    v_mfma_f32_16x16x32_bf16 v[34:37], a[16:19], v[84:87], v[34:37]
    v_mfma_f32_16x16x32_bf16 v[38:41], a[16:19], v[88:91], v[38:41]
    v_mfma_f32_16x16x32_bf16 v[42:45], a[16:19], v[92:95], v[42:45]
    v_mfma_f32_16x16x32_bf16 v[46:49], a[16:19], v[96:99], v[46:49]
    s_waitcnt vmcnt(4)
    v_mfma_f32_16x16x32_bf16 v[200:203], a[20:23], a[88:91], v[200:203]
    v_lshrrev_b32 v19, 1, v7
    global_load_dwordx2 v[84:85], v19, s[4:5]
    v_mfma_f32_16x16x32_bf16 v[204:207], a[20:23], a[92:95], v[204:207]
    v_lshrrev_b32 v19, 1, v8
    global_load_dwordx2 v[86:87], v19, s[4:5]
    v_mfma_f32_16x16x32_bf16 v[208:211], a[20:23], a[96:99], v[208:211]
    v_lshrrev_b32 v19, 1, v9
    global_load_dwordx2 v[88:89], v19, s[4:5]
    v_mfma_f32_16x16x32_bf16 v[212:215], a[20:23], a[100:103], v[212:215]
    v_lshrrev_b32 v19, 1, v10
    global_load_dwordx2 v[90:91], v19, s[4:5]
    v_mfma_f32_16x16x32_bf16 v[216:219], a[24:27], a[88:91], v[216:219]
    v_lshrrev_b32 v19, 1, v11
    global_load_dwordx2 v[92:93], v19, s[4:5]
    v_mfma_f32_16x16x32_bf16 v[220:223], a[24:27], a[92:95], v[220:223]
    s_lshl_b32 s87, s91, 6
    s_mul_i32 s88, s92, 160
    v_mfma_f32_16x16x32_bf16 v[224:227], a[24:27], a[96:99], v[224:227]
    v_add_u32 v23, 0, v0
    v_mul_u32_u24 v20, 3277, v23
    v_mfma_f32_16x16x32_bf16 v[228:231], a[24:27], a[100:103], v[228:231]
    v_lshrrev_b32 v20, 16, v20
    v_add_u32 v19, s87, v20
    v_mfma_f32_16x16x32_bf16 v[232:235], a[28:31], a[88:91], v[232:235]
    v_lshlrev_b32 v19, 2, v19
    v_add_u32 v19, 11534336, v19
    v_mfma_f32_16x16x32_bf16 v[236:239], a[28:31], a[92:95], v[236:239]
    global_load_dword v94, v19, s[36:37] sc1
    v_mul_u32_u24 v20, 20, v20
    v_mfma_f32_16x16x32_bf16 v[240:243], a[28:31], a[96:99], v[240:243]
    v_sub_u32 v20, v23, v20
    v_lshlrev_b32 v20, 3, v20
    v_mfma_f32_16x16x32_bf16 v[244:247], a[28:31], a[100:103], v[244:247]
    v_add_u32 v20, s88, v20
    global_load_dwordx2 v[52:53], v20, s[20:21]
    v_mfma_f32_16x16x32_bf16 v[248:251], a[32:35], a[88:91], v[248:251]
    v_add_u32 v23, 256, v0
    v_mul_u32_u24 v20, 3277, v23
    v_mfma_f32_16x16x32_bf16 v[252:255], a[32:35], a[92:95], v[252:255]
    v_lshrrev_b32 v20, 16, v20
    v_add_u32 v19, s87, v20
    v_mfma_f32_16x16x32_bf16 v[26:29], a[32:35], a[96:99], v[26:29]
    v_lshlrev_b32 v19, 2, v19
    v_add_u32 v19, 11534336, v19
    v_mfma_f32_16x16x32_bf16 v[30:33], a[32:35], a[100:103], v[30:33]
    global_load_dword v95, v19, s[36:37] sc1
    v_mul_u32_u24 v20, 20, v20
    v_mfma_f32_16x16x32_bf16 v[34:37], a[36:39], a[88:91], v[34:37]
    v_sub_u32 v20, v23, v20
    v_lshlrev_b32 v20, 3, v20
    v_mfma_f32_16x16x32_bf16 v[38:41], a[36:39], a[92:95], v[38:41]
    v_add_u32 v20, s88, v20
    global_load_dwordx2 v[54:55], v20, s[20:21]
    v_mfma_f32_16x16x32_bf16 v[42:45], a[36:39], a[96:99], v[42:45]
    v_add_u32 v23, 512, v0
    v_mul_u32_u24 v20, 3277, v23
    v_mfma_f32_16x16x32_bf16 v[46:49], a[36:39], a[100:103], v[46:49]
    v_lshrrev_b32 v20, 16, v20
    v_add_u32 v19, s87, v20
    s_waitcnt vmcnt(9)
    v_mfma_f32_16x16x32_bf16 v[200:203], a[40:43], v[100:103], v[200:203]
    v_lshlrev_b32 v19, 2, v19
    v_add_u32 v19, 11534336, v19
    v_mfma_f32_16x16x32_bf16 v[204:207], a[40:43], v[104:107], v[204:207]
    global_load_dword v96, v19, s[36:37] sc1
    v_mul_u32_u24 v20, 20, v20
    v_mfma_f32_16x16x32_bf16 v[208:211], a[40:43], v[108:111], v[208:211]
    v_sub_u32 v20, v23, v20
    v_lshlrev_b32 v20, 3, v20
    v_mfma_f32_16x16x32_bf16 v[212:215], a[40:43], v[112:115], v[212:215]
    v_add_u32 v20, s88, v20
    global_load_dwordx2 v[56:57], v20, s[20:21]
    v_mfma_f32_16x16x32_bf16 v[216:219], a[44:47], v[100:103], v[216:219]
    v_add_u32 v23, 768, v0
    v_mul_u32_u24 v20, 3277, v23
    v_mfma_f32_16x16x32_bf16 v[220:223], a[44:47], v[104:107], v[220:223]
    v_lshrrev_b32 v20, 16, v20
    v_add_u32 v19, s87, v20
    v_mfma_f32_16x16x32_bf16 v[224:227], a[44:47], v[108:111], v[224:227]
    v_lshlrev_b32 v19, 2, v19
    v_add_u32 v19, 11534336, v19
    v_mfma_f32_16x16x32_bf16 v[228:231], a[44:47], v[112:115], v[228:231]
    global_load_dword v97, v19, s[36:37] sc1
    v_mul_u32_u24 v20, 20, v20
    v_mfma_f32_16x16x32_bf16 v[232:235], a[48:51], v[100:103], v[232:235]
    v_sub_u32 v20, v23, v20
    v_lshlrev_b32 v20, 3, v20
    v_mfma_f32_16x16x32_bf16 v[236:239], a[48:51], v[104:107], v[236:239]
    v_add_u32 v20, s88, v20
    global_load_dwordx2 v[58:59], v20, s[20:21]
    v_mfma_f32_16x16x32_bf16 v[240:243], a[48:51], v[108:111], v[240:243]
    v_add_u32 v23, 1024, v0
    v_mul_u32_u24 v20, 3277, v23
    v_mfma_f32_16x16x32_bf16 v[244:247], a[48:51], v[112:115], v[244:247]
    v_lshrrev_b32 v20, 16, v20
    v_add_u32 v19, s87, v20
    v_mfma_f32_16x16x32_bf16 v[248:251], a[52:55], v[100:103], v[248:251]
    v_lshlrev_b32 v19, 2, v19
    v_add_u32 v19, 11534336, v19
    v_mfma_f32_16x16x32_bf16 v[252:255], a[52:55], v[104:107], v[252:255]
    global_load_dword v98, v19, s[36:37] sc1
    v_mul_u32_u24 v20, 20, v20
    v_mfma_f32_16x16x32_bf16 v[26:29], a[52:55], v[108:111], v[26:29]
    v_sub_u32 v20, v23, v20
    v_lshlrev_b32 v20, 3, v20
    v_mfma_f32_16x16x32_bf16 v[30:33], a[52:55], v[112:115], v[30:33]
    v_add_u32 v20, s88, v20
    global_load_dwordx2 v[60:61], v20, s[20:21]
    v_mfma_f32_16x16x32_bf16 v[34:37], a[56:59], v[100:103], v[34:37]
    v_mfma_f32_16x16x32_bf16 v[38:41], a[56:59], v[104:107], v[38:41]
    v_mfma_f32_16x16x32_bf16 v[42:45], a[56:59], v[108:111], v[42:45]
    v_mfma_f32_16x16x32_bf16 v[46:49], a[56:59], v[112:115], v[46:49]
    v_pk_add_f32 v[200:201], v[200:201], v[120:121] neg_lo:[0,1] neg_hi:[0,1]
    v_pk_add_f32 v[202:203], v[202:203], v[122:123] neg_lo:[0,1] neg_hi:[0,1]
    v_pk_fma_f32 v[120:121], v[12:13], v[200:201], v[120:121] op_sel_hi:[0,1,1]
    v_pk_fma_f32 v[122:123], v[12:13], v[202:203], v[122:123] op_sel_hi:[0,1,1]
    ds_write_b128 v25, v[120:123] offset:0
    v_pk_add_f32 v[204:205], v[204:205], v[124:125] neg_lo:[0,1] neg_hi:[0,1]
    v_pk_add_f32 v[206:207], v[206:207], v[126:127] neg_lo:[0,1] neg_hi:[0,1]
    v_pk_fma_f32 v[124:125], v[14:15], v[204:205], v[124:125] op_sel_hi:[0,1,1]
    v_pk_fma_f32 v[126:127], v[14:15], v[206:207], v[126:127] op_sel_hi:[0,1,1]
    ds_write_b128 v25, v[124:127] offset:1344
    v_pk_add_f32 v[208:209], v[208:209], v[128:129] neg_lo:[0,1] neg_hi:[0,1]
    v_pk_add_f32 v[210:211], v[210:211], v[130:131] neg_lo:[0,1] neg_hi:[0,1]
    v_pk_fma_f32 v[128:129], v[16:17], v[208:209], v[128:129] op_sel_hi:[0,1,1]
    v_pk_fma_f32 v[130:131], v[16:17], v[210:211], v[130:131] op_sel_hi:[0,1,1]
    ds_write_b128 v25, v[128:131] offset:2688
    v_pk_add_f32 v[212:213], v[212:213], v[132:133] neg_lo:[0,1] neg_hi:[0,1]
    v_pk_add_f32 v[214:215], v[214:215], v[134:135] neg_lo:[0,1] neg_hi:[0,1]
    v_pk_fma_f32 v[132:133], v[22:23], v[212:213], v[132:133] op_sel_hi:[0,1,1]
    v_pk_fma_f32 v[134:135], v[22:23], v[214:215], v[134:135] op_sel_hi:[0,1,1]
    ds_write_b128 v25, v[132:135] offset:4032
    v_pk_add_f32 v[216:217], v[216:217], v[136:137] neg_lo:[0,1] neg_hi:[0,1]
    v_pk_add_f32 v[218:219], v[218:219], v[138:139] neg_lo:[0,1] neg_hi:[0,1]
    v_pk_fma_f32 v[136:137], v[12:13], v[216:217], v[136:137] op_sel_hi:[0,1,1]
    v_pk_fma_f32 v[138:139], v[12:13], v[218:219], v[138:139] op_sel_hi:[0,1,1]
    ds_write_b128 v25, v[136:139] offset:64
    v_pk_add_f32 v[220:221], v[220:221], v[140:141] neg_lo:[0,1] neg_hi:[0,1]
    v_pk_add_f32 v[222:223], v[222:223], v[142:143] neg_lo:[0,1] neg_hi:[0,1]
    v_pk_fma_f32 v[140:141], v[14:15], v[220:221], v[140:141] op_sel_hi:[0,1,1]
    v_pk_fma_f32 v[142:143], v[14:15], v[222:223], v[142:143] op_sel_hi:[0,1,1]
    ds_write_b128 v25, v[140:143] offset:1408
    v_pk_add_f32 v[224:225], v[224:225], v[144:145] neg_lo:[0,1] neg_hi:[0,1]
    v_pk_add_f32 v[226:227], v[226:227], v[146:147] neg_lo:[0,1] neg_hi:[0,1]
    v_pk_fma_f32 v[144:145], v[16:17], v[224:225], v[144:145] op_sel_hi:[0,1,1]
    v_pk_fma_f32 v[146:147], v[16:17], v[226:227], v[146:147] op_sel_hi:[0,1,1]
    ds_write_b128 v25, v[144:147] offset:2752
    v_pk_add_f32 v[228:229], v[228:229], v[148:149] neg_lo:[0,1] neg_hi:[0,1]
    v_pk_add_f32 v[230:231], v[230:231], v[150:151] neg_lo:[0,1] neg_hi:[0,1]
    v_pk_fma_f32 v[148:149], v[22:23], v[228:229], v[148:149] op_sel_hi:[0,1,1]
    v_pk_fma_f32 v[150:151], v[22:23], v[230:231], v[150:151] op_sel_hi:[0,1,1]
    ds_write_b128 v25, v[148:151] offset:4096
    v_pk_add_f32 v[232:233], v[232:233], v[152:153] neg_lo:[0,1] neg_hi:[0,1]
    v_pk_add_f32 v[234:235], v[234:235], v[154:155] neg_lo:[0,1] neg_hi:[0,1]
    v_pk_fma_f32 v[152:153], v[12:13], v[232:233], v[152:153] op_sel_hi:[0,1,1]
    v_pk_fma_f32 v[154:155], v[12:13], v[234:235], v[154:155] op_sel_hi:[0,1,1]
    ds_write_b128 v25, v[152:155] offset:128
    v_pk_add_f32 v[236:237], v[236:237], v[156:157] neg_lo:[0,1] neg_hi:[0,1]
    v_pk_add_f32 v[238:239], v[238:239], v[158:159] neg_lo:[0,1] neg_hi:[0,1]
    v_pk_fma_f32 v[156:157], v[14:15], v[236:237], v[156:157] op_sel_hi:[0,1,1]
    v_pk_fma_f32 v[158:159], v[14:15], v[238:239], v[158:159] op_sel_hi:[0,1,1]
    ds_write_b128 v25, v[156:159] offset:1472
    v_pk_add_f32 v[240:241], v[240:241], v[160:161] neg_lo:[0,1] neg_hi:[0,1]
    v_pk_add_f32 v[242:243], v[242:243], v[162:163] neg_lo:[0,1] neg_hi:[0,1]
    v_pk_fma_f32 v[160:161], v[16:17], v[240:241], v[160:161] op_sel_hi:[0,1,1]
    v_pk_fma_f32 v[162:163], v[16:17], v[242:243], v[162:163] op_sel_hi:[0,1,1]
    ds_write_b128 v25, v[160:163] offset:2816
    v_pk_add_f32 v[244:245], v[244:245], v[164:165] neg_lo:[0,1] neg_hi:[0,1]
    v_pk_add_f32 v[246:247], v[246:247], v[166:167] neg_lo:[0,1] neg_hi:[0,1]
    v_pk_fma_f32 v[164:165], v[22:23], v[244:245], v[164:165] op_sel_hi:[0,1,1]
    v_pk_fma_f32 v[166:167], v[22:23], v[246:247], v[166:167] op_sel_hi:[0,1,1]
    ds_write_b128 v25, v[164:167] offset:4160
    v_pk_add_f32 v[248:249], v[248:249], v[168:169] neg_lo:[0,1] neg_hi:[0,1]
    v_pk_add_f32 v[250:251], v[250:251], v[170:171] neg_lo:[0,1] neg_hi:[0,1]
    v_pk_fma_f32 v[168:169], v[12:13], v[248:249], v[168:169] op_sel_hi:[0,1,1]
    v_pk_fma_f32 v[170:171], v[12:13], v[250:251], v[170:171] op_sel_hi:[0,1,1]
    ds_write_b128 v25, v[168:171] offset:192
    v_pk_add_f32 v[252:253], v[252:253], v[172:173] neg_lo:[0,1] neg_hi:[0,1]
    v_pk_add_f32 v[254:255], v[254:255], v[174:175] neg_lo:[0,1] neg_hi:[0,1]
    v_pk_fma_f32 v[172:173], v[14:15], v[252:253], v[172:173] op_sel_hi:[0,1,1]
    v_pk_fma_f32 v[174:175], v[14:15], v[254:255], v[174:175] op_sel_hi:[0,1,1]
    ds_write_b128 v25, v[172:175] offset:1536
    v_pk_add_f32 v[26:27], v[26:27], v[176:177] neg_lo:[0,1] neg_hi:[0,1]
    v_pk_add_f32 v[28:29], v[28:29], v[178:179] neg_lo:[0,1] neg_hi:[0,1]
    v_pk_fma_f32 v[176:177], v[16:17], v[26:27], v[176:177] op_sel_hi:[0,1,1]
    v_pk_fma_f32 v[178:179], v[16:17], v[28:29], v[178:179] op_sel_hi:[0,1,1]
    ds_write_b128 v25, v[176:179] offset:2880
    v_pk_add_f32 v[30:31], v[30:31], v[180:181] neg_lo:[0,1] neg_hi:[0,1]
    v_pk_add_f32 v[32:33], v[32:33], v[182:183] neg_lo:[0,1] neg_hi:[0,1]
    v_pk_fma_f32 v[180:181], v[22:23], v[30:31], v[180:181] op_sel_hi:[0,1,1]
    v_pk_fma_f32 v[182:183], v[22:23], v[32:33], v[182:183] op_sel_hi:[0,1,1]
    ds_write_b128 v25, v[180:183] offset:4224
    v_pk_add_f32 v[34:35], v[34:35], v[184:185] neg_lo:[0,1] neg_hi:[0,1]
    v_pk_add_f32 v[36:37], v[36:37], v[186:187] neg_lo:[0,1] neg_hi:[0,1]
    v_pk_fma_f32 v[184:185], v[12:13], v[34:35], v[184:185] op_sel_hi:[0,1,1]
    v_pk_fma_f32 v[186:187], v[12:13], v[36:37], v[186:187] op_sel_hi:[0,1,1]
    ds_write_b128 v25, v[184:187] offset:256
    v_pk_add_f32 v[38:39], v[38:39], v[188:189] neg_lo:[0,1] neg_hi:[0,1]
    v_pk_add_f32 v[40:41], v[40:41], v[190:191] neg_lo:[0,1] neg_hi:[0,1]
    v_pk_fma_f32 v[188:189], v[14:15], v[38:39], v[188:189] op_sel_hi:[0,1,1]
    v_pk_fma_f32 v[190:191], v[14:15], v[40:41], v[190:191] op_sel_hi:[0,1,1]
    ds_write_b128 v25, v[188:191] offset:1600
    v_pk_add_f32 v[42:43], v[42:43], v[192:193] neg_lo:[0,1] neg_hi:[0,1]
    v_pk_add_f32 v[44:45], v[44:45], v[194:195] neg_lo:[0,1] neg_hi:[0,1]
    v_pk_fma_f32 v[192:193], v[16:17], v[42:43], v[192:193] op_sel_hi:[0,1,1]
    v_pk_fma_f32 v[194:195], v[16:17], v[44:45], v[194:195] op_sel_hi:[0,1,1]
    ds_write_b128 v25, v[192:195] offset:2944
    v_pk_add_f32 v[46:47], v[46:47], v[196:197] neg_lo:[0,1] neg_hi:[0,1]
    v_pk_add_f32 v[48:49], v[48:49], v[198:199] neg_lo:[0,1] neg_hi:[0,1]
    v_pk_fma_f32 v[196:197], v[22:23], v[46:47], v[196:197] op_sel_hi:[0,1,1]
    v_pk_fma_f32 v[198:199], v[22:23], v[48:49], v[198:199] op_sel_hi:[0,1,1]
    ds_write_b128 v25, v[196:199] offset:4288
    s_waitcnt lgkmcnt(0)
    s_barrier
    ds_read_b128 v[120:123], v2 offset:0
    ds_read_b128 v[124:127], v2 offset:21760
    ds_read_b128 v[128:131], v2 offset:43520
    ds_read_b128 v[132:135], v2 offset:65280
    ds_read_b128 v[136:139], v3 offset:0
    ds_read_b128 v[140:143], v3 offset:21760
    ds_read_b128 v[144:147], v3 offset:43520
    ds_read_b128 v[148:151], v3 offset:65280
    ds_read_b128 v[152:155], v4 offset:0
    ds_read_b128 v[156:159], v4 offset:21760
    ds_read_b128 v[160:163], v4 offset:43520
    ds_read_b128 v[164:167], v4 offset:65280
    ds_read_b128 v[168:171], v5 offset:0
    ds_read_b128 v[172:175], v5 offset:21760
    ds_read_b128 v[176:179], v5 offset:43520
    ds_read_b128 v[180:183], v5 offset:65280
    ds_read_b128 v[184:187], v6 offset:0
    ds_read_b128 v[188:191], v6 offset:21760
    ds_read_b128 v[192:195], v6 offset:43520
    ds_read_b128 v[196:199], v6 offset:65280
    s_waitcnt vmcnt(0)
    s_waitcnt lgkmcnt(15)
    v_pk_add_f32 v[120:121], v[120:121], v[124:125]
    v_pk_add_f32 v[122:123], v[122:123], v[126:127]
    v_pk_add_f32 v[128:129], v[128:129], v[132:133]
    v_pk_add_f32 v[130:131], v[130:131], v[134:135]
    v_pk_add_f32 v[120:121], v[120:121], v[128:129]
    v_pk_add_f32 v[122:123], v[122:123], v[130:131]
    v_lshlrev_b32 v20, 16, v84
    v_and_b32 v21, 0xffff0000, v84
    v_lshlrev_b32 v22, 16, v52
    v_and_b32 v23, 0xffff0000, v52
    v_mul_f32 v20, v20, v22
    v_mul_f32 v21, v21, v23
    v_fmac_f32 v120, v94, v20
    v_fmac_f32 v121, v94, v21
    v_lshlrev_b32 v20, 16, v85
    v_and_b32 v21, 0xffff0000, v85
    v_lshlrev_b32 v22, 16, v53
    v_and_b32 v23, 0xffff0000, v53
    v_mul_f32 v20, v20, v22
    v_mul_f32 v21, v21, v23
    v_fmac_f32 v122, v94, v20
    v_fmac_f32 v123, v94, v21
    global_store_dwordx4 v7, v[120:123], s[32:33] nt
    s_waitcnt lgkmcnt(12)
    v_pk_add_f32 v[136:137], v[136:137], v[140:141]
    v_pk_add_f32 v[138:139], v[138:139], v[142:143]
    v_pk_add_f32 v[144:145], v[144:145], v[148:149]
    v_pk_add_f32 v[146:147], v[146:147], v[150:151]
    v_pk_add_f32 v[136:137], v[136:137], v[144:145]
    v_pk_add_f32 v[138:139], v[138:139], v[146:147]
    v_lshlrev_b32 v20, 16, v86
    v_and_b32 v21, 0xffff0000, v86
    v_lshlrev_b32 v22, 16, v54
    v_and_b32 v23, 0xffff0000, v54
    v_mul_f32 v20, v20, v22
    v_mul_f32 v21, v21, v23
    v_fmac_f32 v136, v95, v20
    v_fmac_f32 v137, v95, v21
    v_lshlrev_b32 v20, 16, v87
    v_and_b32 v21, 0xffff0000, v87
    v_lshlrev_b32 v22, 16, v55
    v_and_b32 v23, 0xffff0000, v55
    v_mul_f32 v20, v20, v22
    v_mul_f32 v21, v21, v23
    v_fmac_f32 v138, v95, v20
    v_fmac_f32 v139, v95, v21
    global_store_dwordx4 v8, v[136:139], s[32:33] nt
    s_waitcnt lgkmcnt(8)
    v_pk_add_f32 v[152:153], v[152:153], v[156:157]
    v_pk_add_f32 v[154:155], v[154:155], v[158:159]
    v_pk_add_f32 v[160:161], v[160:161], v[164:165]
    v_pk_add_f32 v[162:163], v[162:163], v[166:167]
    v_pk_add_f32 v[152:153], v[152:153], v[160:161]
    v_pk_add_f32 v[154:155], v[154:155], v[162:163]
    v_lshlrev_b32 v20, 16, v88
    v_and_b32 v21, 0xffff0000, v88
    v_lshlrev_b32 v22, 16, v56
    v_and_b32 v23, 0xffff0000, v56
    v_mul_f32 v20, v20, v22
    v_mul_f32 v21, v21, v23
    v_fmac_f32 v152, v96, v20
    v_fmac_f32 v153, v96, v21
    v_lshlrev_b32 v20, 16, v89
    v_and_b32 v21, 0xffff0000, v89
    v_lshlrev_b32 v22, 16, v57
    v_and_b32 v23, 0xffff0000, v57
    v_mul_f32 v20, v20, v22
    v_mul_f32 v21, v21, v23
    v_fmac_f32 v154, v96, v20
    v_fmac_f32 v155, v96, v21
    global_store_dwordx4 v9, v[152:155], s[32:33] nt
    s_waitcnt lgkmcnt(4)
    v_pk_add_f32 v[168:169], v[168:169], v[172:173]
    v_pk_add_f32 v[170:171], v[170:171], v[174:175]
    v_pk_add_f32 v[176:177], v[176:177], v[180:181]
    v_pk_add_f32 v[178:179], v[178:179], v[182:183]
    v_pk_add_f32 v[168:169], v[168:169], v[176:177]
    v_pk_add_f32 v[170:171], v[170:171], v[178:179]
    v_lshlrev_b32 v20, 16, v90
    v_and_b32 v21, 0xffff0000, v90
    v_lshlrev_b32 v22, 16, v58
    v_and_b32 v23, 0xffff0000, v58
    v_mul_f32 v20, v20, v22
    v_mul_f32 v21, v21, v23
    v_fmac_f32 v168, v97, v20
    v_fmac_f32 v169, v97, v21
    v_lshlrev_b32 v20, 16, v91
    v_and_b32 v21, 0xffff0000, v91
    v_lshlrev_b32 v22, 16, v59
    v_and_b32 v23, 0xffff0000, v59
    v_mul_f32 v20, v20, v22
    v_mul_f32 v21, v21, v23
    v_fmac_f32 v170, v97, v20
    v_fmac_f32 v171, v97, v21
    global_store_dwordx4 v10, v[168:171], s[32:33] nt
    s_waitcnt lgkmcnt(0)
    v_pk_add_f32 v[184:185], v[184:185], v[188:189]
    v_pk_add_f32 v[186:187], v[186:187], v[190:191]
    v_pk_add_f32 v[192:193], v[192:193], v[196:197]
    v_pk_add_f32 v[194:195], v[194:195], v[198:199]
    v_pk_add_f32 v[184:185], v[184:185], v[192:193]
    v_pk_add_f32 v[186:187], v[186:187], v[194:195]
    v_lshlrev_b32 v20, 16, v92
    v_and_b32 v21, 0xffff0000, v92
    v_lshlrev_b32 v22, 16, v60
    v_and_b32 v23, 0xffff0000, v60
    v_mul_f32 v20, v20, v22
    v_mul_f32 v21, v21, v23
    v_fmac_f32 v184, v98, v20
    v_fmac_f32 v185, v98, v21
    v_lshlrev_b32 v20, 16, v93
    v_and_b32 v21, 0xffff0000, v93
    v_lshlrev_b32 v22, 16, v61
    v_and_b32 v23, 0xffff0000, v61
    v_mul_f32 v20, v20, v22
    v_mul_f32 v21, v21, v23
    v_fmac_f32 v186, v98, v20
    v_fmac_f32 v187, v98, v21
    global_store_dwordx4 v11, v[184:187], s[32:33] nt
L_end:
    s_endpgm
L_codeend:
.section .rodata,"a"
.p2align 6
.amdhsa_kernel gated_mix__ssm_conv_s5__glu_gated_bilinear__prompt_kernel
  .amdhsa_next_free_vgpr 512
  .amdhsa_next_free_sgpr 102
  .amdhsa_accum_offset 256
  .amdhsa_group_segment_fixed_size 0
  .amdhsa_kernarg_size 136
  .amdhsa_user_sgpr_count 2
  .amdhsa_user_sgpr_kernarg_segment_ptr 1
  .amdhsa_system_sgpr_workgroup_id_x 1
  .amdhsa_float_denorm_mode_32 3
.end_amdhsa_kernel
```
